```python
import torch

def _softmax(x, axis=-1):
    return torch.softmax(x, dim=axis)
def _gelu(x):
    return torch.nn.functional.gelu(x, approximate="tanh")
def _silu(x):
    return torch.nn.functional.silu(x)
def _sigmoid(x):
    return torch.sigmoid(x)
def _layernorm(x, axis=-1, eps=1e-5):
    m = x.mean(dim=axis, keepdim=True)
    v = x.var(dim=axis, keepdim=True, unbiased=False)
    return (x - m) / torch.sqrt(v + eps)
def _scatter_add(tgt, idx, src, axis=0):
    return tgt.clone().index_add_(axis, idx, src)
def _segment_sum(src, seg, n):
    out = torch.zeros((n,) + src.shape[1:], dtype=src.dtype)
    return out.index_add_(0, seg, src)
def _pad(x, pw):
    flat = tuple(v for pair in reversed(pw) for v in pair)
    return torch.nn.functional.pad(x, flat)

kernel_name = 'concat_heads__linear_kernel_hedgehog__ssm_conv_s4__prompt'

def setup_inputs():

    _w = (lambda a: (lambda t: t.to(torch.bfloat16) if t.is_floating_point() else t)(torch.as_tensor(a)))
    def _A_setup():
        B, S, D, H = 1, 2048, 448, 16
        Dh = D // H
        return {
            "x": _w((lambda *s: torch.randn(*s, dtype=torch.bfloat16) * 0.4)(B, S, D)),
            "wqkv": _w((lambda *s: torch.randn(*s, dtype=torch.bfloat16) * 0.4)(D, 3 * D)),
            "w_phi": _w((lambda *s: torch.randn(*s, dtype=torch.bfloat16) * 0.4)(H, Dh, Dh) * (Dh ** -0.5)),
            "wo": _w((lambda *s: torch.randn(*s, dtype=torch.bfloat16) * 0.05)(D, D)),
        }
    _A_in = _A_setup()

    def _B_setup():
        B, L, D, N = 1, 2048, 448, 256
        A_re = -(lambda _x: torch.exp(torch.as_tensor(_x)))((lambda *s: torch.randn(*s, dtype=torch.bfloat16) * 3.2)(D, N))
        A_im = torch.pi * (lambda *s: torch.randn(*s, dtype=torch.bfloat16) * 0.2)(D, N)
        B_re = (lambda *s: torch.randn(*s, dtype=torch.bfloat16) * 0.4)(D, N)
        B_im = (lambda *s: torch.randn(*s, dtype=torch.bfloat16) * 0.4)(D, N)
        C_re = (lambda *s: torch.randn(*s, dtype=torch.bfloat16) * 0.4)(D, N)
        C_im = (lambda *s: torch.randn(*s, dtype=torch.bfloat16) * 0.4)(D, N)
        log_dt = (lambda *s: torch.randn(*s, dtype=torch.bfloat16) * 0.2)(D) * 0.5 - 4.0
        Dskip = (lambda *s: torch.randn(*s, dtype=torch.bfloat16) * 0.4)(D)
        return {
            "u": _w((lambda *s: torch.randn(*s, dtype=torch.bfloat16) * 0.05)(B, L, D)),
            "A_re": _w(A_re),
            "A_im": _w(A_im),
            "B_re": _w(B_re),
            "B_im": _w(B_im),
            "C_re": _w(C_re),
            "C_im": _w(C_im),
            "log_dt": _w(log_dt),
            "Dskip": _w(Dskip),
        }
    _B_in = _B_setup()

    return {
        "A_x": _A_in["x"],
        "A_wqkv": _A_in["wqkv"],
        "A_w_phi": _A_in["w_phi"],
        "A_wo": _A_in["wo"],
        "B_u": _B_in["u"],
        "B_A_re": _B_in["A_re"],
        "B_A_im": _B_in["A_im"],
        "B_B_re": _B_in["B_re"],
        "B_B_im": _B_in["B_im"],
        "B_C_re": _B_in["C_re"],
        "B_C_im": _B_in["C_im"],
        "B_log_dt": _B_in["log_dt"],
        "B_Dskip": _B_in["Dskip"],
    }

def reference(A_x, A_wqkv, A_w_phi, A_wo, B_u, B_A_re, B_A_im, B_B_re, B_B_im, B_C_re, B_C_im, B_log_dt, B_Dskip):
    def _A_ref(x, wqkv, w_phi, wo):
        B, S, D = x.shape
        H = 16; Dh = D // H
        qkv = (lambda x, *d: x.permute(*d))((x @ wqkv).reshape(B, S, 3, H, Dh), 2, 0, 3, 1, 4)
        q, k, v = qkv[0], qkv[1], qkv[2]
        pq = torch.einsum("bhsd,hdf->bhsf", q, w_phi)
        pk = torch.einsum("bhsd,hdf->bhsf", k, w_phi)
        phi_q = torch.concatenate([_softmax(pq, axis=-1), _softmax(-pq, axis=-1)], axis=-1)
        phi_k = torch.concatenate([_softmax(pk, axis=-1), _softmax(-pk, axis=-1)], axis=-1)
        kv = torch.einsum("bhsf,bhsd->bhfd", phi_k, v)
        z  = torch.einsum("bhsf->bhf", phi_k)
        num = torch.einsum("bhqf,bhfd->bhqd", phi_q, kv)
        den = torch.einsum("bhqf,bhf->bhq", phi_q, z)[..., None] + 1e-6
        o = num / den
        return (lambda x, *d: x.permute(*d))(o, 0, 2, 1, 3).reshape(B, S, D) @ wo

    def _B_ref(u, A_re, A_im, B_re, B_im, C_re, C_im, log_dt, Dskip):
        Bsz, L, D = u.shape
        dt = torch.exp(log_dt)[:, None]
        A = A_re + 1j * A_im
        Bc = B_re + 1j * B_im
        Cc = C_re + 1j * C_im
        logdA = dt * A
        dB = dt * Bc
        l = (lambda x, dt: x.to(dt))(torch.arange(L), A_re.dtype)
        P = torch.exp(logdA[:, :, None] * l[None, None, :])
        K = torch.einsum("dn,dnl,dn->dl", Cc, P, dB).real
        L2 = 2 * L
        Kp = _pad(K, ((0, 0), (0, L)))
        up = (lambda x, *d: x.permute(*d))(u, 0, 2, 1)
        up = _pad(up, ((0, 0), (0, 0), (0, L)))
        Kf = (lambda x, axes=(-2,-1): torch.fft.rfft2(x.float(), dim=axes))(Kp[:, None, :], axes=(-2, -1))
        Uf = (lambda x, axes=(-2,-1): torch.fft.rfft2(x.float(), dim=axes))(up[:, :, None, :], axes=(-2, -1))
        Yf = Uf * Kf[None, :, :, :]
        y = (lambda x, s, axes=(-2,-1): torch.fft.irfft2(x, s=s, dim=axes).to(torch.bfloat16))(Yf, (1, L2), axes=(-2, -1))[:, :, 0, :L]
        y = (lambda x, *d: x.permute(*d))(y, 0, 2, 1) + u * Dskip[None, None, :]
        return y

    a = _A_ref(A_x, A_wqkv, A_w_phi, A_wo)
    b = _B_ref(B_u, B_A_re, B_A_im, B_B_re, B_B_im, B_C_re, B_C_im, B_log_dt, B_Dskip)
    return torch.concatenate([a, b], axis=-1)
```

```asm
; @launch kernel=hh_k4_kernel grid=(480,1,1) block=(256,1,1) lds=81920
.amdgcn_target "amdgcn-amd-amdhsa--gfx950"
.text
.globl hh_k4_kernel
.p2align 8
.type hh_k4_kernel,@function
hh_k4_kernel:
    s_cmp_ge_u32 s2, 480
    s_cbranch_scc1 hh_k4_kernel_end
    s_load_dwordx2 s[54:55], s[0:1], 112
    s_cmp_ge_u32 s2, 256
    s_cbranch_scc1 hh_k4_kernel_b1
    s_load_dwordx4 s[4:7], s[0:1], 0
    s_load_dwordx2 s[8:9], s[0:1], 16
    s_load_dwordx2 s[10:11], s[0:1], 120
    s_setprio 1
    v_lshrrev_b32 v2, 6, v0
    v_and_b32 v1, 63, v0
    v_readfirstlane_b32 s12, v2
    s_and_b32 s36, s2, 7
    s_lshr_b32 s37, s2, 3
    s_and_b32 s14, s36, 3
    s_lshl_b32 s14, s14, 2
    s_and_b32 s13, s37, 3
    s_add_u32 s14, s14, s13
    s_lshr_b32 s13, s36, 2
    s_lshl_b32 s13, s13, 3
    s_lshr_b32 s37, s37, 2
    s_add_u32 s13, s13, s37
    v_lshrrev_b32 v2, 3, v1
    v_and_b32 v3, 7, v1
    v_lshrrev_b32 v4, 4, v1
    s_lshl_b32 s36, s12, 5
    v_add_u32 v5, s36, v2
    v_mul_u32_u24 v5, 896, v5
    v_xor_b32 v6, v3, v4
    v_xor_b32 v7, 4, v6
    v_lshl_add_u32 v10, v6, 4, v5
    v_lshl_add_u32 v11, v7, 4, v5
    v_add_u32 v11, 7168, v11
    v_add_u32 v12, 14336, v10
    v_add_u32 v13, 14336, v11
    s_mul_i32 s36, s12, 192
    s_mul_i32 s37, s13, 56
    s_mov_b32 s41, 43691
    v_add_u32 v2, s36, v1
    v_mul_u32_u24 v3, s41, v2
    v_lshrrev_b32 v3, 19, v3
    v_mul_u32_u24 v4, 12, v3
    v_sub_u32 v4, v2, v4
    v_lshrrev_b32 v5, 2, v4
    v_and_b32 v4, 3, v4
    v_mul_u32_u24 v5, 896, v5
    v_mul_u32_u24 v3, 2688, v3
    v_lshl_add_u32 v4, v4, 4, v5
    v_add3_u32 v14, v3, v4, s37
    v_add_u32 v2, s36, v1
    v_add_u32 v2, 64, v2
    v_mul_u32_u24 v3, s41, v2
    v_lshrrev_b32 v3, 19, v3
    v_mul_u32_u24 v4, 12, v3
    v_sub_u32 v4, v2, v4
    v_lshrrev_b32 v5, 2, v4
    v_and_b32 v4, 3, v4
    v_mul_u32_u24 v5, 896, v5
    v_mul_u32_u24 v3, 2688, v3
    v_lshl_add_u32 v4, v4, 4, v5
    v_add3_u32 v15, v3, v4, s37
    v_add_u32 v2, s36, v1
    v_add_u32 v2, 128, v2
    v_mul_u32_u24 v3, s41, v2
    v_lshrrev_b32 v3, 19, v3
    v_mul_u32_u24 v4, 12, v3
    v_sub_u32 v4, v2, v4
    v_lshrrev_b32 v5, 2, v4
    v_and_b32 v4, 3, v4
    v_mul_u32_u24 v5, 896, v5
    v_mul_u32_u24 v3, 2688, v3
    v_lshl_add_u32 v4, v4, 4, v5
    v_add3_u32 v16, v3, v4, s37
    s_lshl_b32 s36, s12, 10
    v_lshlrev_b32 v2, 4, v1
    v_add_u32 v22, s36, v2
    s_lshl_b32 s38, s12, 12
    s_mul_i32 s39, s12, 3072
    s_waitcnt lgkmcnt(0)
    s_mul_i32 s36, s14, 114688
    s_add_u32 s16, s4, s36
    s_addc_u32 s17, s5, 0
    s_mov_b32 s18, 114688
    s_mov_b32 s19, 0x00020000
    s_mov_b32 s20, s6
    s_mov_b32 s21, s7
    s_mov_b32 s22, 1204224
    s_mov_b32 s23, 0x00020000
    s_mov_b32 s40, 0
    s_add_u32 m0, s39, 0
    s_nop 0
    buffer_load_dwordx4 v14, s[20:23], s40 offen lds
    s_add_u32 m0, s39, 1024
    s_nop 0
    buffer_load_dwordx4 v15, s[20:23], s40 offen lds
    s_add_u32 m0, s39, 2048
    s_nop 0
    buffer_load_dwordx4 v16, s[20:23], s40 offen lds
    s_add_u32 m0, s38, 49152
    s_nop 0
    buffer_load_dwordx4 v10, s[16:19], 0 offen lds
    s_add_u32 m0, s38, 50176
    s_nop 0
    buffer_load_dwordx4 v11, s[16:19], 0 offen lds
    s_add_u32 m0, s38, 51200
    s_nop 0
    buffer_load_dwordx4 v12, s[16:19], 0 offen lds
    s_add_u32 m0, s38, 52224
    s_nop 0
    buffer_load_dwordx4 v13, s[16:19], 0 offen lds
    s_mov_b32 s40, 172032
    s_add_u32 m0, s39, 12288
    s_nop 0
    buffer_load_dwordx4 v14, s[20:23], s40 offen lds
    s_add_u32 m0, s39, 13312
    s_nop 0
    buffer_load_dwordx4 v15, s[20:23], s40 offen lds
    s_add_u32 m0, s39, 14336
    s_nop 0
    buffer_load_dwordx4 v16, s[20:23], s40 offen lds
    s_add_u32 m0, s38, 65408
    s_nop 0
    buffer_load_dwordx4 v10, s[16:19], 0 offen offset:128 lds
    s_add_u32 m0, s38, 66432
    s_nop 0
    buffer_load_dwordx4 v11, s[16:19], 0 offen offset:128 lds
    s_add_u32 m0, s38, 67456
    s_nop 0
    buffer_load_dwordx4 v12, s[16:19], 0 offen offset:128 lds
    s_add_u32 m0, s38, 68480
    s_nop 0
    buffer_load_dwordx4 v13, s[16:19], 0 offen offset:128 lds
    s_mov_b32 s40, 344064
    s_add_u32 m0, s39, 24576
    s_nop 0
    buffer_load_dwordx4 v14, s[20:23], s40 offen lds
    s_add_u32 m0, s39, 25600
    s_nop 0
    buffer_load_dwordx4 v15, s[20:23], s40 offen lds
    s_add_u32 m0, s39, 26624
    s_nop 0
    buffer_load_dwordx4 v16, s[20:23], s40 offen lds
    s_mov_b32 s40, 516096
    s_add_u32 m0, s39, 36864
    s_nop 0
    buffer_load_dwordx4 v14, s[20:23], s40 offen lds
    s_add_u32 m0, s39, 37888
    s_nop 0
    buffer_load_dwordx4 v15, s[20:23], s40 offen lds
    s_add_u32 m0, s39, 38912
    s_nop 0
    buffer_load_dwordx4 v16, s[20:23], s40 offen lds
    s_mul_i32 s36, s13, 1568
    s_add_u32 s24, s8, s36
    s_addc_u32 s25, s9, 0
    s_mov_b32 s26, 1568
    s_mov_b32 s27, 0x00020000
    s_lshl_b32 s36, s13, 4
    s_add_u32 s36, s36, s14
    s_lshl_b32 s37, s36, 13
    s_add_u32 s28, s10, s37
    s_addc_u32 s29, s11, 0
    s_mov_b32 s30, 8192
    s_mov_b32 s31, 0x00020000
    s_lshl_b32 s37, s36, 12
    s_add_u32 s37, s37, 2097152
    s_add_u32 s32, s10, s37
    s_addc_u32 s33, s11, 0
    s_mov_b32 s34, 4096
    s_mov_b32 s35, 0x00020000
    s_mov_b32 s42, 0x3fb8aa3b
    s_mov_b32 s43, 0xbfb8aa3b
    s_mov_b32 s44, 0
    s_mov_b32 s45, -1
    v_and_b32 v2, 31, v1
    v_lshrrev_b32 v3, 5, v1
    v_bfe_u32 v4, v1, 1, 3
    s_add_u32 s36, s38, 49152
    v_lshl_add_u32 v5, v2, 7, s36
    v_or_b32 v6, 0, v3
    v_xor_b32 v6, v6, v4
    v_lshl_add_u32 v17, v6, 4, v5
    v_or_b32 v6, 2, v3
    v_xor_b32 v6, v6, v4
    v_lshl_add_u32 v18, v6, 4, v5
    v_or_b32 v6, 4, v3
    v_xor_b32 v6, v6, v4
    v_lshl_add_u32 v19, v6, 4, v5
    v_or_b32 v6, 6, v3
    v_xor_b32 v6, v6, v4
    v_lshl_add_u32 v20, v6, 4, v5
    v_bfe_u32 v4, v1, 2, 2
    v_lshl_add_u32 v4, v3, 3, v4
    v_mul_u32_u24 v4, 192, v4
    v_bfe_u32 v5, v1, 4, 1
    v_lshl_add_u32 v4, v5, 5, v4
    v_and_b32 v5, 3, v1
    v_lshl_add_u32 v21, v5, 3, v4
    s_waitcnt vmcnt(13)
    s_barrier
    ds_read_b128 v[72:75], v17 offset:0
    ds_read_b128 v[76:79], v18 offset:0
    ds_read_b128 v[80:83], v19 offset:0
    ds_read_b128 v[84:87], v20 offset:0
    ds_read_b64_tr_b16 v[88:89], v21 offset:0
    ds_read_b64_tr_b16 v[90:91], v21 offset:768
    ds_read_b64_tr_b16 v[92:93], v21 offset:64
    ds_read_b64_tr_b16 v[94:95], v21 offset:832
    ds_read_b64_tr_b16 v[96:97], v21 offset:128
    ds_read_b64_tr_b16 v[98:99], v21 offset:896
    ds_read_b64_tr_b16 v[100:101], v21 offset:3072
    ds_read_b64_tr_b16 v[102:103], v21 offset:3840
    ds_read_b64_tr_b16 v[104:105], v21 offset:3136
    ds_read_b64_tr_b16 v[106:107], v21 offset:3904
    ds_read_b64_tr_b16 v[108:109], v21 offset:3200
    ds_read_b64_tr_b16 v[110:111], v21 offset:3968
    s_waitcnt lgkmcnt(6)
    s_add_u32 m0, s38, 48896
    v_mfma_f32_32x32x16_bf16 v[24:39], v[88:91], v[72:75], 0
    buffer_load_dwordx4 v10, s[16:19], 0 offen offset:256 lds
    s_add_u32 m0, s38, 49920
    v_mfma_f32_32x32x16_bf16 v[40:55], v[92:95], v[72:75], 0
    buffer_load_dwordx4 v11, s[16:19], 0 offen offset:256 lds
    s_add_u32 m0, s38, 50944
    v_mfma_f32_32x32x16_bf16 v[56:71], v[72:75], v[96:99], 0
    buffer_load_dwordx4 v12, s[16:19], 0 offen offset:256 lds
    s_add_u32 m0, s38, 51968
    s_nop 0
    buffer_load_dwordx4 v13, s[16:19], 0 offen offset:256 lds
    ds_read_b64_tr_b16 v[112:113], v21 offset:6144
    ds_read_b64_tr_b16 v[114:115], v21 offset:6912
    ds_read_b64_tr_b16 v[116:117], v21 offset:6208
    ds_read_b64_tr_b16 v[118:119], v21 offset:6976
    ds_read_b64_tr_b16 v[120:121], v21 offset:6272
    ds_read_b64_tr_b16 v[122:123], v21 offset:7040
    s_waitcnt lgkmcnt(6)
    v_mfma_f32_32x32x16_bf16 v[24:39], v[100:103], v[76:79], v[24:39]
    v_mfma_f32_32x32x16_bf16 v[40:55], v[104:107], v[76:79], v[40:55]
    v_mfma_f32_32x32x16_bf16 v[56:71], v[76:79], v[108:111], v[56:71]
    ds_read_b64_tr_b16 v[124:125], v21 offset:9216
    ds_read_b64_tr_b16 v[126:127], v21 offset:9984
    ds_read_b64_tr_b16 v[128:129], v21 offset:9280
    ds_read_b64_tr_b16 v[130:131], v21 offset:10048
    ds_read_b64_tr_b16 v[132:133], v21 offset:9344
    ds_read_b64_tr_b16 v[134:135], v21 offset:10112
    s_waitcnt lgkmcnt(6)
    v_mfma_f32_32x32x16_bf16 v[24:39], v[112:115], v[80:83], v[24:39]
    v_mfma_f32_32x32x16_bf16 v[40:55], v[116:119], v[80:83], v[40:55]
    v_mfma_f32_32x32x16_bf16 v[56:71], v[80:83], v[120:123], v[56:71]
    s_waitcnt lgkmcnt(0)
    v_mfma_f32_32x32x16_bf16 v[24:39], v[124:127], v[84:87], v[24:39]
    v_mfma_f32_32x32x16_bf16 v[40:55], v[128:131], v[84:87], v[40:55]
    v_mfma_f32_32x32x16_bf16 v[56:71], v[84:87], v[132:135], v[56:71]
    s_waitcnt vmcnt(10)
    s_barrier
    s_mov_b32 s40, 688128
    s_add_u32 m0, s39, 0
    ds_read_b128 v[72:75], v17 offset:16384
    buffer_load_dwordx4 v14, s[20:23], s40 offen lds
    s_add_u32 m0, s39, 1024
    ds_read_b128 v[76:79], v18 offset:16384
    buffer_load_dwordx4 v15, s[20:23], s40 offen lds
    s_add_u32 m0, s39, 2048
    ds_read_b128 v[80:83], v19 offset:16384
    buffer_load_dwordx4 v16, s[20:23], s40 offen lds
    ds_read_b128 v[84:87], v20 offset:16384
    ds_read_b64_tr_b16 v[88:89], v21 offset:12288
    ds_read_b64_tr_b16 v[90:91], v21 offset:13056
    ds_read_b64_tr_b16 v[92:93], v21 offset:12352
    ds_read_b64_tr_b16 v[94:95], v21 offset:13120
    ds_read_b64_tr_b16 v[96:97], v21 offset:12416
    ds_read_b64_tr_b16 v[98:99], v21 offset:13184
    ds_read_b64_tr_b16 v[100:101], v21 offset:15360
    ds_read_b64_tr_b16 v[102:103], v21 offset:16128
    ds_read_b64_tr_b16 v[104:105], v21 offset:15424
    ds_read_b64_tr_b16 v[106:107], v21 offset:16192
    ds_read_b64_tr_b16 v[108:109], v21 offset:15488
    ds_read_b64_tr_b16 v[110:111], v21 offset:16256
    s_waitcnt lgkmcnt(6)
    s_add_u32 m0, s38, 65152
    v_mfma_f32_32x32x16_bf16 v[24:39], v[88:91], v[72:75], v[24:39]
    buffer_load_dwordx4 v10, s[16:19], 0 offen offset:384 lds
    s_add_u32 m0, s38, 66176
    v_mfma_f32_32x32x16_bf16 v[40:55], v[92:95], v[72:75], v[40:55]
    buffer_load_dwordx4 v11, s[16:19], 0 offen offset:384 lds
    s_add_u32 m0, s38, 67200
    v_mfma_f32_32x32x16_bf16 v[56:71], v[72:75], v[96:99], v[56:71]
    buffer_load_dwordx4 v12, s[16:19], 0 offen offset:384 lds
    s_add_u32 m0, s38, 68224
    s_nop 0
    buffer_load_dwordx4 v13, s[16:19], 0 offen offset:384 lds
    ds_read_b64_tr_b16 v[112:113], v21 offset:18432
    ds_read_b64_tr_b16 v[114:115], v21 offset:19200
    ds_read_b64_tr_b16 v[116:117], v21 offset:18496
    ds_read_b64_tr_b16 v[118:119], v21 offset:19264
    ds_read_b64_tr_b16 v[120:121], v21 offset:18560
    ds_read_b64_tr_b16 v[122:123], v21 offset:19328
    s_waitcnt lgkmcnt(6)
    v_mfma_f32_32x32x16_bf16 v[24:39], v[100:103], v[76:79], v[24:39]
    v_mfma_f32_32x32x16_bf16 v[40:55], v[104:107], v[76:79], v[40:55]
    v_mfma_f32_32x32x16_bf16 v[56:71], v[76:79], v[108:111], v[56:71]
    ds_read_b64_tr_b16 v[124:125], v21 offset:21504
    ds_read_b64_tr_b16 v[126:127], v21 offset:22272
    ds_read_b64_tr_b16 v[128:129], v21 offset:21568
    ds_read_b64_tr_b16 v[130:131], v21 offset:22336
    ds_read_b64_tr_b16 v[132:133], v21 offset:21632
    ds_read_b64_tr_b16 v[134:135], v21 offset:22400
    s_waitcnt lgkmcnt(6)
    v_mfma_f32_32x32x16_bf16 v[24:39], v[112:115], v[80:83], v[24:39]
    v_mfma_f32_32x32x16_bf16 v[40:55], v[116:119], v[80:83], v[40:55]
    v_mfma_f32_32x32x16_bf16 v[56:71], v[80:83], v[120:123], v[56:71]
    s_waitcnt lgkmcnt(0)
    v_mfma_f32_32x32x16_bf16 v[24:39], v[124:127], v[84:87], v[24:39]
    v_mfma_f32_32x32x16_bf16 v[40:55], v[128:131], v[84:87], v[40:55]
    v_mfma_f32_32x32x16_bf16 v[56:71], v[84:87], v[132:135], v[56:71]
    s_waitcnt vmcnt(7)
    s_barrier
    s_mov_b32 s40, 860160
    s_add_u32 m0, s39, 12288
    ds_read_b128 v[72:75], v17 offset:0
    buffer_load_dwordx4 v14, s[20:23], s40 offen lds
    s_add_u32 m0, s39, 13312
    ds_read_b128 v[76:79], v18 offset:0
    buffer_load_dwordx4 v15, s[20:23], s40 offen lds
    s_add_u32 m0, s39, 14336
    ds_read_b128 v[80:83], v19 offset:0
    buffer_load_dwordx4 v16, s[20:23], s40 offen lds
    ds_read_b128 v[84:87], v20 offset:0
    ds_read_b64_tr_b16 v[88:89], v21 offset:24576
    ds_read_b64_tr_b16 v[90:91], v21 offset:25344
    ds_read_b64_tr_b16 v[92:93], v21 offset:24640
    ds_read_b64_tr_b16 v[94:95], v21 offset:25408
    ds_read_b64_tr_b16 v[96:97], v21 offset:24704
    ds_read_b64_tr_b16 v[98:99], v21 offset:25472
    ds_read_b64_tr_b16 v[100:101], v21 offset:27648
    ds_read_b64_tr_b16 v[102:103], v21 offset:28416
    ds_read_b64_tr_b16 v[104:105], v21 offset:27712
    ds_read_b64_tr_b16 v[106:107], v21 offset:28480
    ds_read_b64_tr_b16 v[108:109], v21 offset:27776
    ds_read_b64_tr_b16 v[110:111], v21 offset:28544
    s_waitcnt lgkmcnt(6)
    s_add_u32 m0, s38, 48640
    v_mfma_f32_32x32x16_bf16 v[24:39], v[88:91], v[72:75], v[24:39]
    buffer_load_dwordx4 v10, s[16:19], 0 offen offset:512 lds
    s_add_u32 m0, s38, 49664
    v_mfma_f32_32x32x16_bf16 v[40:55], v[92:95], v[72:75], v[40:55]
    buffer_load_dwordx4 v11, s[16:19], 0 offen offset:512 lds
    s_add_u32 m0, s38, 50688
    v_mfma_f32_32x32x16_bf16 v[56:71], v[72:75], v[96:99], v[56:71]
    buffer_load_dwordx4 v12, s[16:19], 0 offen offset:512 lds
    s_add_u32 m0, s38, 51712
    s_nop 0
    buffer_load_dwordx4 v13, s[16:19], 0 offen offset:512 lds
    ds_read_b64_tr_b16 v[112:113], v21 offset:30720
    ds_read_b64_tr_b16 v[114:115], v21 offset:31488
    ds_read_b64_tr_b16 v[116:117], v21 offset:30784
    ds_read_b64_tr_b16 v[118:119], v21 offset:31552
    ds_read_b64_tr_b16 v[120:121], v21 offset:30848
    ds_read_b64_tr_b16 v[122:123], v21 offset:31616
    s_waitcnt lgkmcnt(6)
    v_mfma_f32_32x32x16_bf16 v[24:39], v[100:103], v[76:79], v[24:39]
    v_mfma_f32_32x32x16_bf16 v[40:55], v[104:107], v[76:79], v[40:55]
    v_mfma_f32_32x32x16_bf16 v[56:71], v[76:79], v[108:111], v[56:71]
    ds_read_b64_tr_b16 v[124:125], v21 offset:33792
    ds_read_b64_tr_b16 v[126:127], v21 offset:34560
    ds_read_b64_tr_b16 v[128:129], v21 offset:33856
    ds_read_b64_tr_b16 v[130:131], v21 offset:34624
    ds_read_b64_tr_b16 v[132:133], v21 offset:33920
    ds_read_b64_tr_b16 v[134:135], v21 offset:34688
    s_waitcnt lgkmcnt(6)
    v_mfma_f32_32x32x16_bf16 v[24:39], v[112:115], v[80:83], v[24:39]
    v_mfma_f32_32x32x16_bf16 v[40:55], v[116:119], v[80:83], v[40:55]
    v_mfma_f32_32x32x16_bf16 v[56:71], v[80:83], v[120:123], v[56:71]
    s_waitcnt lgkmcnt(0)
    v_mfma_f32_32x32x16_bf16 v[24:39], v[124:127], v[84:87], v[24:39]
    v_mfma_f32_32x32x16_bf16 v[40:55], v[128:131], v[84:87], v[40:55]
    v_mfma_f32_32x32x16_bf16 v[56:71], v[84:87], v[132:135], v[56:71]
    s_waitcnt vmcnt(7)
    s_barrier
    s_mov_b32 s40, 1032192
    s_add_u32 m0, s39, 24576
    ds_read_b128 v[72:75], v17 offset:16384
    buffer_load_dwordx4 v14, s[20:23], s40 offen lds
    s_add_u32 m0, s39, 25600
    ds_read_b128 v[76:79], v18 offset:16384
    buffer_load_dwordx4 v15, s[20:23], s40 offen lds
    s_add_u32 m0, s39, 26624
    ds_read_b128 v[80:83], v19 offset:16384
    buffer_load_dwordx4 v16, s[20:23], s40 offen lds
    ds_read_b128 v[84:87], v20 offset:16384
    ds_read_b64_tr_b16 v[88:89], v21 offset:36864
    ds_read_b64_tr_b16 v[90:91], v21 offset:37632
    ds_read_b64_tr_b16 v[92:93], v21 offset:36928
    ds_read_b64_tr_b16 v[94:95], v21 offset:37696
    ds_read_b64_tr_b16 v[96:97], v21 offset:36992
    ds_read_b64_tr_b16 v[98:99], v21 offset:37760
    ds_read_b64_tr_b16 v[100:101], v21 offset:39936
    ds_read_b64_tr_b16 v[102:103], v21 offset:40704
    ds_read_b64_tr_b16 v[104:105], v21 offset:40000
    ds_read_b64_tr_b16 v[106:107], v21 offset:40768
    ds_read_b64_tr_b16 v[108:109], v21 offset:40064
    ds_read_b64_tr_b16 v[110:111], v21 offset:40832
    s_waitcnt lgkmcnt(6)
    s_add_u32 m0, s38, 64896
    v_mfma_f32_32x32x16_bf16 v[24:39], v[88:91], v[72:75], v[24:39]
    buffer_load_dwordx4 v10, s[16:19], 0 offen offset:640 lds
    s_add_u32 m0, s38, 65920
    v_mfma_f32_32x32x16_bf16 v[40:55], v[92:95], v[72:75], v[40:55]
    buffer_load_dwordx4 v11, s[16:19], 0 offen offset:640 lds
    s_add_u32 m0, s38, 66944
    v_mfma_f32_32x32x16_bf16 v[56:71], v[72:75], v[96:99], v[56:71]
    buffer_load_dwordx4 v12, s[16:19], 0 offen offset:640 lds
    s_add_u32 m0, s38, 67968
    s_nop 0
    buffer_load_dwordx4 v13, s[16:19], 0 offen offset:640 lds
    ds_read_b64_tr_b16 v[112:113], v21 offset:43008
    ds_read_b64_tr_b16 v[114:115], v21 offset:43776
    ds_read_b64_tr_b16 v[116:117], v21 offset:43072
    ds_read_b64_tr_b16 v[118:119], v21 offset:43840
    ds_read_b64_tr_b16 v[120:121], v21 offset:43136
    ds_read_b64_tr_b16 v[122:123], v21 offset:43904
    s_waitcnt lgkmcnt(6)
    v_mfma_f32_32x32x16_bf16 v[24:39], v[100:103], v[76:79], v[24:39]
    v_mfma_f32_32x32x16_bf16 v[40:55], v[104:107], v[76:79], v[40:55]
    v_mfma_f32_32x32x16_bf16 v[56:71], v[76:79], v[108:111], v[56:71]
    ds_read_b64_tr_b16 v[124:125], v21 offset:46080
    ds_read_b64_tr_b16 v[126:127], v21 offset:46848
    ds_read_b64_tr_b16 v[128:129], v21 offset:46144
    ds_read_b64_tr_b16 v[130:131], v21 offset:46912
    ds_read_b64_tr_b16 v[132:133], v21 offset:46208
    ds_read_b64_tr_b16 v[134:135], v21 offset:46976
    s_waitcnt lgkmcnt(6)
    v_mfma_f32_32x32x16_bf16 v[24:39], v[112:115], v[80:83], v[24:39]
    v_mfma_f32_32x32x16_bf16 v[40:55], v[116:119], v[80:83], v[40:55]
    v_mfma_f32_32x32x16_bf16 v[56:71], v[80:83], v[120:123], v[56:71]
    s_waitcnt lgkmcnt(0)
    v_mfma_f32_32x32x16_bf16 v[24:39], v[124:127], v[84:87], v[24:39]
    v_mfma_f32_32x32x16_bf16 v[40:55], v[128:131], v[84:87], v[40:55]
    v_mfma_f32_32x32x16_bf16 v[56:71], v[84:87], v[132:135], v[56:71]
    s_waitcnt vmcnt(7)
    s_barrier
    s_lshl_b32 s36, s12, 10
    s_add_u32 m0, s36, 36864
    ds_read_b128 v[72:75], v17 offset:0
    buffer_load_dwordx4 v22, s[24:27], 0 offen lds
    ds_read_b128 v[76:79], v18 offset:0
    ds_read_b128 v[80:83], v19 offset:0
    ds_read_b128 v[84:87], v20 offset:0
    ds_read_b64_tr_b16 v[88:89], v21 offset:0
    ds_read_b64_tr_b16 v[90:91], v21 offset:768
    ds_read_b64_tr_b16 v[92:93], v21 offset:64
    ds_read_b64_tr_b16 v[94:95], v21 offset:832
    ds_read_b64_tr_b16 v[96:97], v21 offset:128
    ds_read_b64_tr_b16 v[98:99], v21 offset:896
    ds_read_b64_tr_b16 v[100:101], v21 offset:3072
    ds_read_b64_tr_b16 v[102:103], v21 offset:3840
    ds_read_b64_tr_b16 v[104:105], v21 offset:3136
    ds_read_b64_tr_b16 v[106:107], v21 offset:3904
    ds_read_b64_tr_b16 v[108:109], v21 offset:3200
    ds_read_b64_tr_b16 v[110:111], v21 offset:3968
    s_waitcnt lgkmcnt(6)
    s_add_u32 m0, s38, 48384
    v_mfma_f32_32x32x16_bf16 v[24:39], v[88:91], v[72:75], v[24:39]
    buffer_load_dwordx4 v10, s[16:19], 0 offen offset:768 lds
    s_add_u32 m0, s38, 49408
    v_mfma_f32_32x32x16_bf16 v[40:55], v[92:95], v[72:75], v[40:55]
    buffer_load_dwordx4 v11, s[16:19], 0 offen offset:768 lds
    s_add_u32 m0, s38, 50432
    v_mfma_f32_32x32x16_bf16 v[56:71], v[72:75], v[96:99], v[56:71]
    buffer_load_dwordx4 v12, s[16:19], 0 offen offset:768 lds
    s_add_u32 m0, s38, 51456
    s_nop 0
    buffer_load_dwordx4 v13, s[16:19], 0 offen offset:768 lds
    ds_read_b64_tr_b16 v[112:113], v21 offset:6144
    ds_read_b64_tr_b16 v[114:115], v21 offset:6912
    ds_read_b64_tr_b16 v[116:117], v21 offset:6208
    ds_read_b64_tr_b16 v[118:119], v21 offset:6976
    ds_read_b64_tr_b16 v[120:121], v21 offset:6272
    ds_read_b64_tr_b16 v[122:123], v21 offset:7040
    s_waitcnt lgkmcnt(6)
    v_mfma_f32_32x32x16_bf16 v[24:39], v[100:103], v[76:79], v[24:39]
    v_mfma_f32_32x32x16_bf16 v[40:55], v[104:107], v[76:79], v[40:55]
    v_mfma_f32_32x32x16_bf16 v[56:71], v[76:79], v[108:111], v[56:71]
    ds_read_b64_tr_b16 v[124:125], v21 offset:9216
    ds_read_b64_tr_b16 v[126:127], v21 offset:9984
    ds_read_b64_tr_b16 v[128:129], v21 offset:9280
    ds_read_b64_tr_b16 v[130:131], v21 offset:10048
    ds_read_b64_tr_b16 v[132:133], v21 offset:9344
    ds_read_b64_tr_b16 v[134:135], v21 offset:10112
    s_waitcnt lgkmcnt(6)
    v_mfma_f32_32x32x16_bf16 v[24:39], v[112:115], v[80:83], v[24:39]
    v_mfma_f32_32x32x16_bf16 v[40:55], v[116:119], v[80:83], v[40:55]
    v_mfma_f32_32x32x16_bf16 v[56:71], v[80:83], v[120:123], v[56:71]
    s_waitcnt lgkmcnt(0)
    v_mfma_f32_32x32x16_bf16 v[24:39], v[124:127], v[84:87], v[24:39]
    v_mfma_f32_32x32x16_bf16 v[40:55], v[128:131], v[84:87], v[40:55]
    v_mfma_f32_32x32x16_bf16 v[56:71], v[84:87], v[132:135], v[56:71]
    s_waitcnt vmcnt(5)
    s_barrier
    ds_read_b128 v[72:75], v17 offset:16384
    ds_read_b128 v[76:79], v18 offset:16384
    ds_read_b128 v[80:83], v19 offset:16384
    ds_read_b128 v[84:87], v20 offset:16384
    ds_read_b64_tr_b16 v[88:89], v21 offset:12288
    ds_read_b64_tr_b16 v[90:91], v21 offset:13056
    ds_read_b64_tr_b16 v[92:93], v21 offset:12352
    ds_read_b64_tr_b16 v[94:95], v21 offset:13120
    ds_read_b64_tr_b16 v[96:97], v21 offset:12416
    ds_read_b64_tr_b16 v[98:99], v21 offset:13184
    ds_read_b64_tr_b16 v[100:101], v21 offset:15360
    ds_read_b64_tr_b16 v[102:103], v21 offset:16128
    ds_read_b64_tr_b16 v[104:105], v21 offset:15424
    ds_read_b64_tr_b16 v[106:107], v21 offset:16192
    ds_read_b64_tr_b16 v[108:109], v21 offset:15488
    ds_read_b64_tr_b16 v[110:111], v21 offset:16256
    s_waitcnt lgkmcnt(6)
    v_mfma_f32_32x32x16_bf16 v[24:39], v[88:91], v[72:75], v[24:39]
    v_mfma_f32_32x32x16_bf16 v[40:55], v[92:95], v[72:75], v[40:55]
    v_mfma_f32_32x32x16_bf16 v[56:71], v[72:75], v[96:99], v[56:71]
    ds_read_b64_tr_b16 v[112:113], v21 offset:18432
    ds_read_b64_tr_b16 v[114:115], v21 offset:19200
    ds_read_b64_tr_b16 v[116:117], v21 offset:18496
    ds_read_b64_tr_b16 v[118:119], v21 offset:19264
    ds_read_b64_tr_b16 v[120:121], v21 offset:18560
    ds_read_b64_tr_b16 v[122:123], v21 offset:19328
    s_waitcnt lgkmcnt(6)
    v_mfma_f32_32x32x16_bf16 v[24:39], v[100:103], v[76:79], v[24:39]
    v_mfma_f32_32x32x16_bf16 v[40:55], v[104:107], v[76:79], v[40:55]
    v_mfma_f32_32x32x16_bf16 v[56:71], v[76:79], v[108:111], v[56:71]
    ds_read_b64_tr_b16 v[124:125], v21 offset:21504
    ds_read_b64_tr_b16 v[126:127], v21 offset:22272
    ds_read_b64_tr_b16 v[128:129], v21 offset:21568
    ds_read_b64_tr_b16 v[130:131], v21 offset:22336
    ds_read_b64_tr_b16 v[132:133], v21 offset:21632
    ds_read_b64_tr_b16 v[134:135], v21 offset:22400
    s_waitcnt lgkmcnt(6)
    v_mfma_f32_32x32x16_bf16 v[24:39], v[112:115], v[80:83], v[24:39]
    v_mfma_f32_32x32x16_bf16 v[40:55], v[116:119], v[80:83], v[40:55]
    v_mfma_f32_32x32x16_bf16 v[56:71], v[80:83], v[120:123], v[56:71]
    s_waitcnt lgkmcnt(0)
    v_mfma_f32_32x32x16_bf16 v[24:39], v[124:127], v[84:87], v[24:39]
    v_mfma_f32_32x32x16_bf16 v[40:55], v[128:131], v[84:87], v[40:55]
    v_mfma_f32_32x32x16_bf16 v[56:71], v[84:87], v[132:135], v[56:71]
    s_waitcnt vmcnt(0)
    s_barrier
    ds_read_b128 v[72:75], v17 offset:0
    ds_read_b128 v[76:79], v18 offset:0
    ds_read_b128 v[80:83], v19 offset:0
    ds_read_b128 v[84:87], v20 offset:0
    ds_read_b64_tr_b16 v[88:89], v21 offset:24576
    ds_read_b64_tr_b16 v[90:91], v21 offset:25344
    ds_read_b64_tr_b16 v[92:93], v21 offset:24640
    ds_read_b64_tr_b16 v[94:95], v21 offset:25408
    ds_read_b64_tr_b16 v[96:97], v21 offset:24704
    ds_read_b64_tr_b16 v[98:99], v21 offset:25472
    ds_read_b64_tr_b16 v[100:101], v21 offset:27648
    ds_read_b64_tr_b16 v[102:103], v21 offset:28416
    ds_read_b64_tr_b16 v[104:105], v21 offset:27712
    ds_read_b64_tr_b16 v[106:107], v21 offset:28480
    ds_read_b64_tr_b16 v[108:109], v21 offset:27776
    ds_read_b64_tr_b16 v[110:111], v21 offset:28544
    s_waitcnt lgkmcnt(6)
    v_mfma_f32_32x32x16_bf16 v[24:39], v[88:91], v[72:75], v[24:39]
    v_mfma_f32_32x32x16_bf16 v[40:55], v[92:95], v[72:75], v[40:55]
    v_mfma_f32_32x32x16_bf16 v[56:71], v[72:75], v[96:99], v[56:71]
    ds_read_b64_tr_b16 v[112:113], v21 offset:30720
    ds_read_b64_tr_b16 v[114:115], v21 offset:31488
    ds_read_b64_tr_b16 v[116:117], v21 offset:30784
    ds_read_b64_tr_b16 v[118:119], v21 offset:31552
    ds_read_b64_tr_b16 v[120:121], v21 offset:30848
    ds_read_b64_tr_b16 v[122:123], v21 offset:31616
    s_waitcnt lgkmcnt(6)
    v_mfma_f32_32x32x16_bf16 v[24:39], v[100:103], v[76:79], v[24:39]
    v_mfma_f32_32x32x16_bf16 v[40:55], v[104:107], v[76:79], v[40:55]
    v_mfma_f32_32x32x16_bf16 v[56:71], v[76:79], v[108:111], v[56:71]
    ds_read_b64_tr_b16 v[124:125], v21 offset:33792
    ds_read_b64_tr_b16 v[126:127], v21 offset:34560
    ds_read_b64_tr_b16 v[128:129], v21 offset:33856
    ds_read_b64_tr_b16 v[130:131], v21 offset:34624
    ds_read_b64_tr_b16 v[132:133], v21 offset:33920
    ds_read_b64_tr_b16 v[134:135], v21 offset:34688
    s_waitcnt lgkmcnt(6)
    v_mfma_f32_32x32x16_bf16 v[24:39], v[112:115], v[80:83], v[24:39]
    v_mfma_f32_32x32x16_bf16 v[40:55], v[116:119], v[80:83], v[40:55]
    v_mfma_f32_32x32x16_bf16 v[56:71], v[80:83], v[120:123], v[56:71]
    s_waitcnt lgkmcnt(0)
    v_mfma_f32_32x32x16_bf16 v[24:39], v[124:127], v[84:87], v[24:39]
    v_mfma_f32_32x32x16_bf16 v[40:55], v[128:131], v[84:87], v[40:55]
    v_mfma_f32_32x32x16_bf16 v[56:71], v[84:87], v[132:135], v[56:71]
    v_bfe_u32 v4, v1, 2, 2
    v_lshl_add_u32 v4, v3, 2, v4
    v_mul_u32_u24 v4, 56, v4
    v_bfe_u32 v5, v1, 4, 1
    v_lshl_add_u32 v4, v5, 5, v4
    v_and_b32 v5, 3, v1
    v_lshl_add_u32 v4, v5, 3, v4
    ds_read_b64_tr_b16 v[72:73], v4 offset:36864
    ds_read_b64_tr_b16 v[74:75], v4 offset:37312
    ds_read_b64_tr_b16 v[76:77], v4 offset:37760
    ds_read_b64_tr_b16 v[78:79], v4 offset:38208
    s_lshl_b32 s36, s12, 2
    v_add_u32 v5, s36, v3
    v_and_b32 v6, 15, v1
    v_xor_b32 v5, v5, v6
    v_lshlrev_b32 v5, 4, v5
    v_lshl_add_u32 v10, v2, 8, v5
    v_bfe_u32 v5, v2, 1, 2
    v_lshlrev_b32 v5, 2, v5
    v_bfe_u32 v7, v2, 3, 1
    v_lshl_or_b32 v5, v7, 1, v5
    v_and_b32 v7, 1, v2
    v_or_b32 v5, v5, v7
    v_xor_b32 v5, v5, v3
    v_lshlrev_b32 v5, 3, v5
    v_lshl_add_u32 v5, v2, 7, v5
    s_lshl_b32 s36, s12, 12
    s_add_u32 s36, s36, 65536
    v_add_u32 v11, s36, v5
    v_lshrrev_b32 v5, 4, v1
    v_bfe_u32 v7, v1, 2, 2
    v_lshl_add_u32 v5, v5, 2, v7
    v_bfe_u32 v7, v5, 1, 2
    v_lshlrev_b32 v7, 2, v7
    v_bfe_u32 v8, v5, 3, 1
    v_lshl_or_b32 v7, v8, 1, v7
    v_and_b32 v8, 1, v5
    v_or_b32 v7, v7, v8
    v_and_b32 v8, 3, v1
    s_lshl_b32 s36, s12, 2
    v_add_u32 v8, s36, v8
    v_xor_b32 v7, v7, v8
    v_lshlrev_b32 v7, 3, v7
    v_lshl_add_u32 v7, v5, 7, v7
    v_add_u32 v12, 65536, v7
    v_lshrrev_b32 v5, 4, v1
    v_xor_b32 v5, v5, v6
    v_lshlrev_b32 v5, 4, v5
    v_lshl_add_u32 v5, v6, 8, v5
    v_xor_b32 v13, 0, v5
    v_xor_b32 v14, 64, v5
    v_xor_b32 v15, 128, v5
    v_xor_b32 v16, 192, v5
    s_lshl_b32 s36, s12, 10
    v_lshlrev_b32 v5, 4, v1
    v_add_u32 v17, s36, v5
    s_lshl_b32 s36, s12, 11
    v_lshlrev_b32 v5, 4, v1
    v_add_u32 v18, s36, v5
    v_cvt_pk_bf16_f32 v80, v24, v25
    v_cvt_pk_bf16_f32 v81, v26, v27
    v_cvt_pk_bf16_f32 v82, v28, v29
    v_cvt_pk_bf16_f32 v83, v30, v31
    v_cvt_pk_bf16_f32 v84, v32, v33
    v_cvt_pk_bf16_f32 v85, v34, v35
    v_cvt_pk_bf16_f32 v86, v36, v37
    v_cvt_pk_bf16_f32 v87, v38, v39
    v_cvt_pk_bf16_f32 v88, v40, v41
    v_cvt_pk_bf16_f32 v89, v42, v43
    v_cvt_pk_bf16_f32 v90, v44, v45
    v_cvt_pk_bf16_f32 v91, v46, v47
    v_cvt_pk_bf16_f32 v92, v48, v49
    v_cvt_pk_bf16_f32 v93, v50, v51
    v_cvt_pk_bf16_f32 v94, v52, v53
    v_cvt_pk_bf16_f32 v95, v54, v55
    s_waitcnt lgkmcnt(0)
    v_mfma_f32_32x32x16_bf16 v[40:55], v[72:75], v[88:91], 0
    v_mfma_f32_32x32x16_bf16 v[24:39], v[72:75], v[80:83], 0
    v_mfma_f32_32x32x16_bf16 v[40:55], v[76:79], v[92:95], v[40:55]
    v_mfma_f32_32x32x16_bf16 v[24:39], v[76:79], v[84:87], v[24:39]
    v_cvt_pk_bf16_f32 v96, v56, v57
    v_cvt_pk_bf16_f32 v97, v58, v59
    v_cvt_pk_bf16_f32 v98, v60, v61
    v_cvt_pk_bf16_f32 v99, v62, v63
    v_cvt_pk_bf16_f32 v100, v64, v65
    v_cvt_pk_bf16_f32 v101, v66, v67
    v_cvt_pk_bf16_f32 v102, v68, v69
    v_cvt_pk_bf16_f32 v103, v70, v71
    v_cmp_eq_u32 vcc, 28, v2
    v_mov_b32 v5, 0x3f803f80
    s_nop 0
    v_cndmask_b32 v96, v96, v5, vcc
    v_cndmask_b32 v97, v97, v5, vcc
    v_cndmask_b32 v98, v98, v5, vcc
    v_cndmask_b32 v99, v99, v5, vcc
    v_cndmask_b32 v100, v100, v5, vcc
    v_cndmask_b32 v101, v101, v5, vcc
    v_cndmask_b32 v102, v102, v5, vcc
    v_cndmask_b32 v103, v103, v5, vcc
    v_xor_b32 v6, 32, v10
    ds_write_b64 v10, v[96:97] offset:0
    ds_write_b64 v6, v[98:99] offset:0
    ds_write_b64 v10, v[100:101] offset:8
    ds_write_b64 v6, v[102:103] offset:8
    v_cvt_pk_bf16_f32 v136, v40, v41
    v_cvt_pk_bf16_f32 v137, v42, v43
    v_cvt_pk_bf16_f32 v138, v44, v45
    v_cvt_pk_bf16_f32 v139, v46, v47
    v_cvt_pk_bf16_f32 v140, v48, v49
    v_cvt_pk_bf16_f32 v141, v50, v51
    v_cvt_pk_bf16_f32 v142, v52, v53
    v_cvt_pk_bf16_f32 v143, v54, v55
    v_lshlrev_b32 v104, 16, v136
    v_and_b32 v105, 0xffff0000, v136
    v_lshlrev_b32 v106, 16, v137
    v_and_b32 v107, 0xffff0000, v137
    v_lshlrev_b32 v108, 16, v138
    v_and_b32 v109, 0xffff0000, v138
    v_lshlrev_b32 v110, 16, v139
    v_and_b32 v111, 0xffff0000, v139
    v_lshlrev_b32 v112, 16, v140
    v_and_b32 v113, 0xffff0000, v140
    v_lshlrev_b32 v114, 16, v141
    v_and_b32 v115, 0xffff0000, v141
    v_lshlrev_b32 v116, 16, v142
    v_and_b32 v117, 0xffff0000, v142
    v_lshlrev_b32 v118, 16, v143
    v_and_b32 v119, 0xffff0000, v143
    v_cvt_pk_bf16_f32 v200, v24, v25
    v_cvt_pk_bf16_f32 v201, v26, v27
    v_cvt_pk_bf16_f32 v202, v28, v29
    v_cvt_pk_bf16_f32 v203, v30, v31
    v_cvt_pk_bf16_f32 v204, v32, v33
    v_cvt_pk_bf16_f32 v205, v34, v35
    v_cvt_pk_bf16_f32 v206, v36, v37
    v_cvt_pk_bf16_f32 v207, v38, v39
    v_cndmask_b32_e64 v116, v116, v104, s[44:45]
    v_cndmask_b32_e64 v117, v117, v104, s[44:45]
    v_cndmask_b32_e64 v118, v118, v104, s[44:45]
    v_cndmask_b32_e64 v119, v119, v104, s[44:45]
    v_max3_f32 v144, v104, v105, v106
    v_min3_f32 v145, v104, v105, v106
    v_max3_f32 v144, v144, v107, v108
    v_min3_f32 v145, v145, v107, v108
    v_max3_f32 v144, v144, v109, v110
    v_min3_f32 v145, v145, v109, v110
    v_max3_f32 v144, v144, v111, v112
    v_min3_f32 v145, v145, v111, v112
    v_max3_f32 v144, v144, v113, v114
    v_min3_f32 v145, v145, v113, v114
    v_max3_f32 v144, v144, v115, v116
    v_min3_f32 v145, v145, v115, v116
    v_max3_f32 v144, v144, v117, v118
    v_min3_f32 v145, v145, v117, v118
    v_max_f32 v144, v144, v119
    v_min_f32 v145, v145, v119
    v_mov_b32 v146, v144
    v_mov_b32 v147, v145
    s_nop 0
    v_permlane32_swap_b32 v144, v146
    v_permlane32_swap_b32 v145, v147
    v_max_f32 v144, v144, v146
    v_min_f32 v145, v145, v147
    v_mul_f32 v144, s43, v144
    v_mul_f32 v145, s42, v145
    v_fma_f32 v120, v104, s42, v144
    v_fma_f32 v121, v105, s42, v144
    v_fma_f32 v122, v106, s42, v144
    v_fma_f32 v123, v107, s42, v144
    v_fma_f32 v124, v108, s42, v144
    v_fma_f32 v125, v109, s42, v144
    v_fma_f32 v126, v110, s42, v144
    v_fma_f32 v127, v111, s42, v144
    v_fma_f32 v128, v112, s42, v144
    v_fma_f32 v129, v113, s42, v144
    v_fma_f32 v130, v114, s42, v144
    v_fma_f32 v131, v115, s42, v144
    v_fma_f32 v132, v116, s42, v144
    v_fma_f32 v133, v117, s42, v144
    v_fma_f32 v134, v118, s42, v144
    v_fma_f32 v135, v119, s42, v144
    v_exp_f32 v120, v120
    v_exp_f32 v121, v121
    v_exp_f32 v122, v122
    v_exp_f32 v123, v123
    v_exp_f32 v124, v124
    v_exp_f32 v125, v125
    v_exp_f32 v126, v126
    v_exp_f32 v127, v127
    v_exp_f32 v128, v128
    v_exp_f32 v129, v129
    v_exp_f32 v130, v130
    v_exp_f32 v131, v131
    v_exp_f32 v132, v132
    v_exp_f32 v133, v133
    v_exp_f32 v134, v134
    v_exp_f32 v135, v135
    v_cndmask_b32_e64 v132, v132, 0, s[44:45]
    v_cndmask_b32_e64 v133, v133, 0, s[44:45]
    v_cndmask_b32_e64 v134, v134, 0, s[44:45]
    v_cndmask_b32_e64 v135, v135, 0, s[44:45]
    v_pk_add_f32 v[148:149], v[120:121], v[122:123]
    v_pk_add_f32 v[150:151], v[124:125], v[126:127]
    v_pk_add_f32 v[148:149], v[148:149], v[128:129]
    v_pk_add_f32 v[150:151], v[150:151], v[130:131]
    v_pk_add_f32 v[148:149], v[148:149], v[132:133]
    v_pk_add_f32 v[150:151], v[150:151], v[134:135]
    v_pk_add_f32 v[148:149], v[148:149], v[150:151]
    v_add_f32 v148, v148, v149
    v_mov_b32 v149, v148
    s_nop 1
    v_permlane32_swap_b32 v148, v149
    v_add_f32 v148, v148, v149
    v_rcp_f32 v148, v148
    s_nop 0
    v_pk_mul_f32 v[120:121], v[120:121], v[148:149] op_sel_hi:[1,0]
    v_pk_mul_f32 v[122:123], v[122:123], v[148:149] op_sel_hi:[1,0]
    v_pk_mul_f32 v[124:125], v[124:125], v[148:149] op_sel_hi:[1,0]
    v_pk_mul_f32 v[126:127], v[126:127], v[148:149] op_sel_hi:[1,0]
    v_pk_mul_f32 v[128:129], v[128:129], v[148:149] op_sel_hi:[1,0]
    v_pk_mul_f32 v[130:131], v[130:131], v[148:149] op_sel_hi:[1,0]
    v_pk_mul_f32 v[132:133], v[132:133], v[148:149] op_sel_hi:[1,0]
    v_pk_mul_f32 v[134:135], v[134:135], v[148:149] op_sel_hi:[1,0]
    v_cvt_pk_bf16_f32 v120, v120, v121
    v_cvt_pk_bf16_f32 v121, v122, v123
    v_cvt_pk_bf16_f32 v122, v124, v125
    v_cvt_pk_bf16_f32 v123, v126, v127
    v_cvt_pk_bf16_f32 v124, v128, v129
    v_cvt_pk_bf16_f32 v125, v130, v131
    v_cvt_pk_bf16_f32 v126, v132, v133
    v_cvt_pk_bf16_f32 v127, v134, v135
    v_xor_b32 v136, 0, v11
    v_xor_b32 v137, 16, v11
    v_xor_b32 v138, 32, v11
    v_xor_b32 v139, 48, v11
    ds_write_b64 v136, v[120:121]
    ds_write_b64 v137, v[122:123]
    ds_write_b64 v138, v[124:125]
    ds_write_b64 v139, v[126:127]
    v_fma_f32 v120, v104, s43, v145
    v_fma_f32 v121, v105, s43, v145
    v_fma_f32 v122, v106, s43, v145
    v_fma_f32 v123, v107, s43, v145
    v_fma_f32 v124, v108, s43, v145
    v_fma_f32 v125, v109, s43, v145
    v_fma_f32 v126, v110, s43, v145
    v_fma_f32 v127, v111, s43, v145
    v_fma_f32 v128, v112, s43, v145
    v_fma_f32 v129, v113, s43, v145
    v_fma_f32 v130, v114, s43, v145
    v_fma_f32 v131, v115, s43, v145
    v_fma_f32 v132, v116, s43, v145
    v_fma_f32 v133, v117, s43, v145
    v_fma_f32 v134, v118, s43, v145
    v_fma_f32 v135, v119, s43, v145
    v_exp_f32 v120, v120
    v_exp_f32 v121, v121
    v_exp_f32 v122, v122
    v_exp_f32 v123, v123
    v_exp_f32 v124, v124
    v_exp_f32 v125, v125
    v_exp_f32 v126, v126
    v_exp_f32 v127, v127
    v_exp_f32 v128, v128
    v_exp_f32 v129, v129
    v_exp_f32 v130, v130
    v_exp_f32 v131, v131
    v_exp_f32 v132, v132
    v_exp_f32 v133, v133
    v_exp_f32 v134, v134
    v_exp_f32 v135, v135
    v_cndmask_b32_e64 v132, v132, 0, s[44:45]
    v_cndmask_b32_e64 v133, v133, 0, s[44:45]
    v_cndmask_b32_e64 v134, v134, 0, s[44:45]
    v_cndmask_b32_e64 v135, v135, 0, s[44:45]
    v_pk_add_f32 v[148:149], v[120:121], v[122:123]
    v_pk_add_f32 v[150:151], v[124:125], v[126:127]
    v_pk_add_f32 v[148:149], v[148:149], v[128:129]
    v_pk_add_f32 v[150:151], v[150:151], v[130:131]
    v_pk_add_f32 v[148:149], v[148:149], v[132:133]
    v_pk_add_f32 v[150:151], v[150:151], v[134:135]
    v_pk_add_f32 v[148:149], v[148:149], v[150:151]
    v_add_f32 v148, v148, v149
    v_mov_b32 v149, v148
    s_nop 1
    v_permlane32_swap_b32 v148, v149
    v_add_f32 v148, v148, v149
    v_rcp_f32 v148, v148
    s_nop 0
    v_pk_mul_f32 v[120:121], v[120:121], v[148:149] op_sel_hi:[1,0]
    v_pk_mul_f32 v[122:123], v[122:123], v[148:149] op_sel_hi:[1,0]
    v_pk_mul_f32 v[124:125], v[124:125], v[148:149] op_sel_hi:[1,0]
    v_pk_mul_f32 v[126:127], v[126:127], v[148:149] op_sel_hi:[1,0]
    v_pk_mul_f32 v[128:129], v[128:129], v[148:149] op_sel_hi:[1,0]
    v_pk_mul_f32 v[130:131], v[130:131], v[148:149] op_sel_hi:[1,0]
    v_pk_mul_f32 v[132:133], v[132:133], v[148:149] op_sel_hi:[1,0]
    v_pk_mul_f32 v[134:135], v[134:135], v[148:149] op_sel_hi:[1,0]
    v_cvt_pk_bf16_f32 v120, v120, v121
    v_cvt_pk_bf16_f32 v121, v122, v123
    v_cvt_pk_bf16_f32 v122, v124, v125
    v_cvt_pk_bf16_f32 v123, v126, v127
    v_cvt_pk_bf16_f32 v124, v128, v129
    v_cvt_pk_bf16_f32 v125, v130, v131
    v_cvt_pk_bf16_f32 v126, v132, v133
    v_cvt_pk_bf16_f32 v127, v134, v135
    v_xor_b32 v136, 64, v11
    v_xor_b32 v137, 80, v11
    v_xor_b32 v138, 96, v11
    v_xor_b32 v139, 112, v11
    ds_write_b64 v136, v[120:121]
    ds_write_b64 v137, v[122:123]
    ds_write_b64 v138, v[124:125]
    ds_write_b64 v139, v[126:127]
    s_waitcnt lgkmcnt(0)
    s_barrier
    ds_read_b64_tr_b16 v[72:73], v12 offset:0
    ds_read_b64_tr_b16 v[74:75], v12 offset:2048
    ds_read_b128 v[88:91], v13 offset:0
    ds_read_b128 v[92:95], v13 offset:4096
    ds_read_b64_tr_b16 v[76:77], v12 offset:4096
    ds_read_b64_tr_b16 v[78:79], v12 offset:6144
    ds_read_b128 v[96:99], v14 offset:0
    ds_read_b128 v[100:103], v14 offset:4096
    ds_read_b64_tr_b16 v[80:81], v12 offset:8192
    ds_read_b64_tr_b16 v[82:83], v12 offset:10240
    ds_read_b128 v[104:107], v15 offset:0
    ds_read_b128 v[108:111], v15 offset:4096
    ds_read_b64_tr_b16 v[84:85], v12 offset:12288
    ds_read_b64_tr_b16 v[86:87], v12 offset:14336
    ds_read_b128 v[112:115], v16 offset:0
    ds_read_b128 v[116:119], v16 offset:4096
    s_waitcnt lgkmcnt(12)
    v_mfma_f32_16x16x32_bf16 v[24:27], v[72:75], v[88:91], 0
    v_mfma_f32_16x16x32_bf16 v[28:31], v[72:75], v[92:95], 0
    s_waitcnt lgkmcnt(8)
    v_mfma_f32_16x16x32_bf16 v[24:27], v[76:79], v[96:99], v[24:27]
    v_mfma_f32_16x16x32_bf16 v[28:31], v[76:79], v[100:103], v[28:31]
    s_waitcnt lgkmcnt(4)
    v_mfma_f32_16x16x32_bf16 v[24:27], v[80:83], v[104:107], v[24:27]
    v_mfma_f32_16x16x32_bf16 v[28:31], v[80:83], v[108:111], v[28:31]
    s_waitcnt lgkmcnt(0)
    v_mfma_f32_16x16x32_bf16 v[24:27], v[84:87], v[112:115], v[24:27]
    v_mfma_f32_16x16x32_bf16 v[28:31], v[84:87], v[116:119], v[28:31]
    s_nop 6
    v_cvt_pk_bf16_f32 v40, v24, v25
    v_cvt_pk_bf16_f32 v41, v26, v27
    v_cvt_pk_bf16_f32 v42, v28, v29
    v_cvt_pk_bf16_f32 v43, v30, v31
    buffer_store_dwordx4 v[40:43], v17, s[32:35], 0 offen sc1
    s_mov_b64 exec, -1
    s_lshl_b32 s36, s13, 10
    s_add_u32 s36, s36, 14712832
    s_add_u32 s16, s10, s36
    s_addc_u32 s17, s11, 0
    s_mov_b32 s18, 1024
    s_mov_b32 s19, 0x00020000
    s_mov_b32 s20, s54
    s_mov_b32 s21, s55
    s_mov_b32 s22, 4
    s_mov_b32 s23, 0x00020000
    v_mov_b32 v2, 0
    s_cmp_eq_u32 s12, 0
    s_cbranch_scc0 hh_k4_kernel_a1e_nold
    s_mov_b64 exec, 1
    buffer_load_dword v3, v2, s[20:23], 0 offen sc1
    s_mov_b64 exec, -1
hh_k4_kernel_a1e_nold:
    s_waitcnt vmcnt(0) lgkmcnt(0)
    s_barrier
    s_cmp_eq_u32 s12, 0
    s_cbranch_scc0 hh_k4_kernel_a1e_nosig
    v_readfirstlane_b32 s37, v3
    s_cmp_lg_u32 s37, 0
    s_cbranch_scc1 hh_k4_kernel_a1e_rdy
    s_mov_b64 exec, 1
    v_mov_b32 v2, 0
    s_mov_b32 s36, 0x100000
hh_k4_kernel_a1e_init:
    buffer_load_dword v3, v2, s[20:23], 0 offen sc1
    s_waitcnt vmcnt(0)
    v_readfirstlane_b32 s37, v3
    s_cmp_ge_u32 s37, 1
    s_cbranch_scc1 hh_k4_kernel_a1e_init_ok
    s_sub_u32 s36, s36, 1
    s_cmp_lg_u32 s36, 0
    s_cbranch_scc1 hh_k4_kernel_a1e_init
hh_k4_kernel_a1e_init_ok:
    s_mov_b64 exec, -1
hh_k4_kernel_a1e_rdy:
    s_mov_b64 exec, 0xff
    v_mov_b32 v3, 1
    v_lshlrev_b32 v2, 7, v1
    buffer_atomic_add v3, v2, s[16:19], 0 offen sc1
    s_mov_b64 exec, -1
hh_k4_kernel_a1e_nosig:
    s_load_dwordx2 s[10:11], s[0:1], 120
    s_load_dwordx2 s[4:5], s[0:1], 24
    s_load_dwordx2 s[6:7], s[0:1], 104
    s_setprio 2
    v_lshrrev_b32 v2, 6, v0
    v_and_b32 v1, 63, v0
    v_readfirstlane_b32 s12, v2
    s_and_b32 s36, s2, 7
    s_lshr_b32 s37, s2, 3
    s_and_b32 s14, s36, 3
    s_lshl_b32 s14, s14, 2
    s_and_b32 s13, s37, 3
    s_add_u32 s14, s14, s13
    s_lshr_b32 s13, s36, 2
    s_lshl_b32 s13, s13, 3
    s_lshr_b32 s37, s37, 2
    s_add_u32 s13, s13, s37
    v_and_b32 v2, 31, v1
    v_lshrrev_b32 v3, 5, v1
    s_lshl_b32 s36, s12, 11
    v_lshlrev_b32 v7, 4, v1
    v_add_u32 v4, s36, v7
    s_lshl_b32 s36, s12, 10
    v_lshlrev_b32 v8, 12, v3
    v_lshl_add_u32 v8, v2, 4, v8
    v_add_u32 v5, s36, v8
    v_add_u32 v7, s36, v7
    v_lshrrev_b32 v9, 3, v1
    s_mul_i32 s36, s12, 112
    v_add_u32 v9, s36, v9
    v_mul_u32_u24 v9, 896, v9
    v_bfe_u32 v10, v1, 4, 1
    v_lshlrev_b32 v10, 2, v10
    v_and_b32 v11, 7, v1
    v_xor_b32 v10, v10, v11
    v_lshl_add_u32 v12, v10, 4, v9
    s_waitcnt lgkmcnt(0)
    s_lshl_b32 s36, s13, 4
    s_add_u32 s37, s36, s14
    s_lshl_b32 s37, s37, 13
    s_add_u32 s16, s10, s37
    s_addc_u32 s17, s11, 0
    s_mov_b32 s18, 8192
    s_mov_b32 s19, 0x00020000
    s_lshl_b32 s37, s13, 16
    s_add_u32 s37, s37, 2097152
    s_add_u32 s20, s10, s37
    s_addc_u32 s21, s11, 0
    s_mov_b32 s22, 65536
    s_mov_b32 s23, 0x00020000
    s_and_b32 s15, s13, 7
    s_lshl_b32 s39, s15, 7
    s_add_u32 s28, s4, s39
    s_addc_u32 s29, s5, 0
    s_mov_b32 s30, 401408
    s_mov_b32 s31, 0x00020000
    s_sub_u32 s30, s30, s39
    s_cmp_eq_u32 s15, 7
    s_cselect_b32 s30, 0, s30
    s_mul_i32 s40, s12, 14336
    s_cmp_eq_u32 s12, 0
    s_cbranch_scc1 hh_k4_kernel_a2nodma
    s_add_u32 m0, s40, 4096
    s_nop 0
    buffer_load_dwordx4 v12, s[28:31], 0 offen lds
    s_mov_b32 s41, 7168
    s_add_u32 m0, s40, 5120
    s_nop 0
    buffer_load_dwordx4 v12, s[28:31], s41 offen lds
    s_mov_b32 s41, 14336
    s_add_u32 m0, s40, 6144
    s_nop 0
    buffer_load_dwordx4 v12, s[28:31], s41 offen lds
    s_mov_b32 s41, 21504
    s_add_u32 m0, s40, 7168
    s_nop 0
    buffer_load_dwordx4 v12, s[28:31], s41 offen lds
    s_mov_b32 s41, 28672
    s_add_u32 m0, s40, 8192
    s_nop 0
    buffer_load_dwordx4 v12, s[28:31], s41 offen lds
    s_mov_b32 s41, 35840
    s_add_u32 m0, s40, 9216
    s_nop 0
    buffer_load_dwordx4 v12, s[28:31], s41 offen lds
    s_mov_b32 s41, 43008
    s_add_u32 m0, s40, 10240
    s_nop 0
    buffer_load_dwordx4 v12, s[28:31], s41 offen lds
    s_mov_b32 s41, 50176
    s_add_u32 m0, s40, 11264
    s_nop 0
    buffer_load_dwordx4 v12, s[28:31], s41 offen lds
    s_mov_b32 s41, 57344
    s_add_u32 m0, s40, 12288
    s_nop 0
    buffer_load_dwordx4 v12, s[28:31], s41 offen lds
    s_mov_b32 s41, 64512
    s_add_u32 m0, s40, 13312
    s_nop 0
    buffer_load_dwordx4 v12, s[28:31], s41 offen lds
    s_mov_b32 s41, 71680
    s_add_u32 m0, s40, 14336
    s_nop 0
    buffer_load_dwordx4 v12, s[28:31], s41 offen lds
    s_mov_b32 s41, 78848
    s_add_u32 m0, s40, 15360
    s_nop 0
    buffer_load_dwordx4 v12, s[28:31], s41 offen lds
    s_mov_b32 s41, 86016
    s_add_u32 m0, s40, 16384
    s_nop 0
    buffer_load_dwordx4 v12, s[28:31], s41 offen lds
    s_mov_b32 s41, 93184
    s_add_u32 m0, s40, 17408
    s_nop 0
    buffer_load_dwordx4 v12, s[28:31], s41 offen lds
    s_mul_i32 s39, s12, 100352
    v_subrev_u32 v10, s39, v12
    s_mul_i32 s39, s12, 5
    s_add_u32 s36, s39, 0xfffffffb
    s_min_u32 s36, s36, 13
    s_mul_i32 s41, s36, 7168
    s_lshl_b32 s36, s36, 10
    s_add_u32 m0, s36, 4096
    s_nop 0
    buffer_load_dwordx4 v10, s[28:31], s41 offen lds
    s_add_u32 s36, s39, 0xfffffffc
    s_min_u32 s36, s36, 13
    s_mul_i32 s41, s36, 7168
    s_lshl_b32 s36, s36, 10
    s_add_u32 m0, s36, 4096
    s_nop 0
    buffer_load_dwordx4 v10, s[28:31], s41 offen lds
    s_add_u32 s36, s39, 0xfffffffd
    s_min_u32 s36, s36, 13
    s_mul_i32 s41, s36, 7168
    s_lshl_b32 s36, s36, 10
    s_add_u32 m0, s36, 4096
    s_nop 0
    buffer_load_dwordx4 v10, s[28:31], s41 offen lds
    s_add_u32 s36, s39, 0xfffffffe
    s_min_u32 s36, s36, 13
    s_mul_i32 s41, s36, 7168
    s_lshl_b32 s36, s36, 10
    s_add_u32 m0, s36, 4096
    s_nop 0
    buffer_load_dwordx4 v10, s[28:31], s41 offen lds
    s_add_u32 s36, s39, 0xffffffff
    s_min_u32 s36, s36, 13
    s_mul_i32 s41, s36, 7168
    s_lshl_b32 s36, s36, 10
    s_add_u32 m0, s36, 4096
    s_nop 0
    buffer_load_dwordx4 v10, s[28:31], s41 offen lds
hh_k4_kernel_a2nodma:
    s_lshl_b32 s36, s13, 10
    s_add_u32 s36, s36, 14712832
    s_add_u32 s48, s10, s36
    s_addc_u32 s49, s11, 0
    s_mov_b32 s50, 1024
    s_mov_b32 s51, 0x00020000
    s_cmp_eq_u32 s12, 0
    s_cbranch_scc0 hh_k4_kernel_a2kv_no
    s_mov_b64 exec, 1
    s_and_b32 s37, s2, 7
    s_lshl_b32 s37, s37, 7
    v_mov_b32 v13, s37
    s_mov_b32 s36, 0x100000
hh_k4_kernel_a2kv:
    buffer_load_dword v14, v13, s[48:51], 0 offen sc1
    s_waitcnt vmcnt(0)
    v_readfirstlane_b32 s37, v14
    s_cmp_ge_u32 s37, 16
    s_cbranch_scc1 hh_k4_kernel_a2kv_ok
    s_sub_u32 s36, s36, 1
    s_cmp_lg_u32 s36, 0
    s_cbranch_scc1 hh_k4_kernel_a2kv
hh_k4_kernel_a2kv_ok:
    s_mov_b64 exec, -1
hh_k4_kernel_a2kv_no:
    s_barrier
    s_add_u32 s36, s14, 0
    s_and_b32 s36, s36, 7
    s_lshl_b32 s48, s36, 13
    s_add_u32 s36, s14, 1
    s_and_b32 s36, s36, 7
    s_lshl_b32 s49, s36, 13
    s_add_u32 s36, s14, 2
    s_and_b32 s36, s36, 7
    s_lshl_b32 s50, s36, 13
    s_add_u32 s36, s14, 3
    s_and_b32 s36, s36, 7
    s_lshl_b32 s51, s36, 13
    s_add_u32 s36, s14, 4
    s_and_b32 s36, s36, 7
    s_lshl_b32 s52, s36, 13
    s_add_u32 s36, s14, 5
    s_and_b32 s36, s36, 7
    s_lshl_b32 s53, s36, 13
    s_add_u32 s36, s14, 6
    s_and_b32 s36, s36, 7
    s_lshl_b32 s54, s36, 13
    s_add_u32 s36, s14, 7
    s_and_b32 s36, s36, 7
    s_lshl_b32 s55, s36, 13
    buffer_load_dwordx4 v[64:67], v5, s[20:23], s48 offen
    buffer_load_dwordx4 v[68:71], v5, s[20:23], s48 offen offset:512
    buffer_load_dwordx4 v[72:75], v5, s[20:23], s49 offen
    buffer_load_dwordx4 v[76:79], v5, s[20:23], s49 offen offset:512
    buffer_load_dwordx4 v[80:83], v5, s[20:23], s50 offen
    buffer_load_dwordx4 v[84:87], v5, s[20:23], s50 offen offset:512
    buffer_load_dwordx4 v[88:91], v5, s[20:23], s51 offen
    buffer_load_dwordx4 v[92:95], v5, s[20:23], s51 offen offset:512
    buffer_load_dwordx4 v[96:99], v5, s[20:23], s52 offen
    buffer_load_dwordx4 v[100:103], v5, s[20:23], s52 offen offset:512
    buffer_load_dwordx4 v[104:107], v5, s[20:23], s53 offen
    buffer_load_dwordx4 v[108:111], v5, s[20:23], s53 offen offset:512
    buffer_load_dwordx4 v[112:115], v5, s[20:23], s54 offen
    buffer_load_dwordx4 v[116:119], v5, s[20:23], s54 offen offset:512
    buffer_load_dwordx4 v[120:123], v5, s[20:23], s55 offen
    buffer_load_dwordx4 v[124:127], v5, s[20:23], s55 offen offset:512
    s_and_b32 s15, s13, 7
    s_lshr_b32 s38, s13, 3
    s_lshl_b32 s39, s15, 7
    s_add_u32 s28, s4, s39
    s_addc_u32 s29, s5, 0
    s_mov_b32 s30, 401408
    s_mov_b32 s31, 0x00020000
    s_sub_u32 s30, s30, s39
    s_cmp_eq_u32 s15, 7
    s_cselect_b32 s30, 0, s30
    s_mul_i32 s40, s12, 14336
    v_mov_b32 v15, v12
    v_mov_b32 v56, 0
    v_mov_b32 v57, 0
    v_mov_b32 v58, 0
    v_mov_b32 v59, 0
    v_lshlrev_b32 v9, 4, v1
    ds_write_b128 v9, v[56:59] offset:61440
    s_lshl_b32 s36, s14, 4
    s_add_u32 s36, s36, s13
    s_lshl_b32 s36, s36, 13
    s_add_u32 s36, s36, 3145728
    s_add_u32 s24, s10, s36
    s_addc_u32 s25, s11, 0
    s_mov_b32 s26, 8192
    s_mov_b32 s27, 0x00020000
    v_mov_b32 v6, v4
    s_lshl_b32 s36, s14, 10
    s_add_u32 s36, s36, 14680064
    s_add_u32 s32, s10, s36
    s_addc_u32 s33, s11, 0
    s_mov_b32 s34, 1024
    s_mov_b32 s35, 0x00020000
    s_lshl_b32 s36, s14, 17
    s_add_u32 s36, s36, 3145728
    s_add_u32 s16, s10, s36
    s_addc_u32 s17, s11, 0
    s_mov_b32 s18, 131072
    s_mov_b32 s19, 0x00020000
    s_lshl_b32 s36, s14, 1
    s_add_u32 s36, s36, s38
    s_mul_i32 s36, s36, 114688
    s_add_u32 s36, s36, s39
    s_add_u32 s20, s6, s36
    s_addc_u32 s21, s7, 0
    s_mov_b32 s22, 113024
    s_mov_b32 s23, 0x00020000
    s_mov_b32 s42, 0x3fb8aa3b
    s_mov_b32 s43, 0xbfb8aa3b
    s_mov_b32 s44, 0
    s_mov_b32 s45, -1
    v_and_b32 v12, 15, v1
    v_bfe_u32 v13, v1, 4, 1
    v_lshlrev_b32 v13, 3, v13
    v_sub_u32 v12, v12, v13
    v_and_b32 v13, 1, v12
    v_lshlrev_b32 v13, 4, v13
    v_mov_b32 v14, 0x3f80
    v_lshlrev_b32 v13, v13, v14
    v_ashrrev_i32 v12, 1, v12
    v_cmp_eq_u32 vcc, 0, v12
    s_nop 1
    v_cndmask_b32 v8, 0, v13, vcc
    v_cmp_eq_u32 vcc, 1, v12
    s_nop 1
    v_cndmask_b32 v9, 0, v13, vcc
    v_cmp_eq_u32 vcc, 2, v12
    s_nop 1
    v_cndmask_b32 v10, 0, v13, vcc
    v_cmp_eq_u32 vcc, 3, v12
    s_nop 1
    v_cndmask_b32 v11, 0, v13, vcc
    v_lshlrev_b32 v24, 16, v200
    v_and_b32 v25, 0xffff0000, v200
    v_lshlrev_b32 v26, 16, v201
    v_and_b32 v27, 0xffff0000, v201
    v_lshlrev_b32 v28, 16, v202
    v_and_b32 v29, 0xffff0000, v202
    v_lshlrev_b32 v30, 16, v203
    v_and_b32 v31, 0xffff0000, v203
    v_lshlrev_b32 v32, 16, v204
    v_and_b32 v33, 0xffff0000, v204
    v_lshlrev_b32 v34, 16, v205
    v_and_b32 v35, 0xffff0000, v205
    v_lshlrev_b32 v36, 16, v206
    v_and_b32 v37, 0xffff0000, v206
    v_lshlrev_b32 v38, 16, v207
    v_and_b32 v39, 0xffff0000, v207
    v_cndmask_b32_e64 v36, v36, v24, s[44:45]
    v_cndmask_b32_e64 v37, v37, v24, s[44:45]
    v_cndmask_b32_e64 v38, v38, v24, s[44:45]
    v_cndmask_b32_e64 v39, v39, v24, s[44:45]
    v_max3_f32 v56, v24, v25, v26
    v_min3_f32 v57, v24, v25, v26
    v_max3_f32 v56, v56, v27, v28
    v_min3_f32 v57, v57, v27, v28
    v_max3_f32 v56, v56, v29, v30
    v_min3_f32 v57, v57, v29, v30
    v_max3_f32 v56, v56, v31, v32
    v_min3_f32 v57, v57, v31, v32
    v_max3_f32 v56, v56, v33, v34
    v_min3_f32 v57, v57, v33, v34
    v_max3_f32 v56, v56, v35, v36
    v_min3_f32 v57, v57, v35, v36
    v_max3_f32 v56, v56, v37, v38
    v_min3_f32 v57, v57, v37, v38
    v_max_f32 v56, v56, v39
    v_min_f32 v57, v57, v39
    v_mov_b32 v58, v56
    v_mov_b32 v59, v57
    s_nop 0
    v_permlane32_swap_b32 v56, v58
    v_permlane32_swap_b32 v57, v59
    v_max_f32 v56, v56, v58
    v_min_f32 v57, v57, v59
    v_mul_f32 v56, s43, v56
    v_mul_f32 v57, s42, v57
    v_fma_f32 v40, v24, s42, v56
    v_fma_f32 v41, v25, s42, v56
    v_fma_f32 v42, v26, s42, v56
    v_fma_f32 v43, v27, s42, v56
    v_fma_f32 v44, v28, s42, v56
    v_fma_f32 v45, v29, s42, v56
    v_fma_f32 v46, v30, s42, v56
    v_fma_f32 v47, v31, s42, v56
    v_fma_f32 v48, v32, s42, v56
    v_fma_f32 v49, v33, s42, v56
    v_fma_f32 v50, v34, s42, v56
    v_fma_f32 v51, v35, s42, v56
    v_fma_f32 v52, v36, s42, v56
    v_fma_f32 v53, v37, s42, v56
    v_fma_f32 v54, v38, s42, v56
    v_fma_f32 v55, v39, s42, v56
    v_exp_f32 v40, v40
    v_exp_f32 v41, v41
    v_exp_f32 v42, v42
    v_exp_f32 v43, v43
    v_exp_f32 v44, v44
    v_exp_f32 v45, v45
    v_exp_f32 v46, v46
    v_exp_f32 v47, v47
    v_exp_f32 v48, v48
    v_exp_f32 v49, v49
    v_exp_f32 v50, v50
    v_exp_f32 v51, v51
    v_exp_f32 v52, v52
    v_exp_f32 v53, v53
    v_exp_f32 v54, v54
    v_exp_f32 v55, v55
    v_cndmask_b32_e64 v52, v52, 0, s[44:45]
    v_cndmask_b32_e64 v53, v53, 0, s[44:45]
    v_cndmask_b32_e64 v54, v54, 0, s[44:45]
    v_cndmask_b32_e64 v55, v55, 0, s[44:45]
    v_pk_add_f32 v[60:61], v[40:41], v[42:43]
    v_pk_add_f32 v[62:63], v[44:45], v[46:47]
    v_pk_add_f32 v[60:61], v[60:61], v[48:49]
    v_pk_add_f32 v[62:63], v[62:63], v[50:51]
    v_pk_add_f32 v[60:61], v[60:61], v[52:53]
    v_pk_add_f32 v[62:63], v[62:63], v[54:55]
    v_pk_add_f32 v[60:61], v[60:61], v[62:63]
    v_add_f32 v60, v60, v61
    v_mov_b32 v61, v60
    s_nop 1
    v_permlane32_swap_b32 v60, v61
    v_add_f32 v60, v60, v61
    v_rcp_f32 v60, v60
    s_nop 0
    v_pk_mul_f32 v[40:41], v[40:41], v[60:61] op_sel_hi:[1,0]
    v_pk_mul_f32 v[42:43], v[42:43], v[60:61] op_sel_hi:[1,0]
    v_pk_mul_f32 v[44:45], v[44:45], v[60:61] op_sel_hi:[1,0]
    v_pk_mul_f32 v[46:47], v[46:47], v[60:61] op_sel_hi:[1,0]
    v_pk_mul_f32 v[48:49], v[48:49], v[60:61] op_sel_hi:[1,0]
    v_pk_mul_f32 v[50:51], v[50:51], v[60:61] op_sel_hi:[1,0]
    v_pk_mul_f32 v[52:53], v[52:53], v[60:61] op_sel_hi:[1,0]
    v_pk_mul_f32 v[54:55], v[54:55], v[60:61] op_sel_hi:[1,0]
    v_cvt_pk_bf16_f32 v40, v40, v41
    v_cvt_pk_bf16_f32 v41, v42, v43
    v_cvt_pk_bf16_f32 v42, v44, v45
    v_cvt_pk_bf16_f32 v43, v46, v47
    v_cvt_pk_bf16_f32 v44, v48, v49
    v_cvt_pk_bf16_f32 v45, v50, v51
    v_cvt_pk_bf16_f32 v46, v52, v53
    v_cvt_pk_bf16_f32 v47, v54, v55
    v_mov_b32 v128, v40
    v_mov_b32 v129, v41
    v_mov_b32 v130, v42
    v_mov_b32 v131, v43
    v_mov_b32 v132, v44
    v_mov_b32 v133, v45
    v_mov_b32 v134, v46
    v_mov_b32 v135, v47
    v_fma_f32 v40, v24, s43, v57
    v_fma_f32 v41, v25, s43, v57
    v_fma_f32 v42, v26, s43, v57
    v_fma_f32 v43, v27, s43, v57
    v_fma_f32 v44, v28, s43, v57
    v_fma_f32 v45, v29, s43, v57
    v_fma_f32 v46, v30, s43, v57
    v_fma_f32 v47, v31, s43, v57
    v_fma_f32 v48, v32, s43, v57
    v_fma_f32 v49, v33, s43, v57
    v_fma_f32 v50, v34, s43, v57
    v_fma_f32 v51, v35, s43, v57
    v_fma_f32 v52, v36, s43, v57
    v_fma_f32 v53, v37, s43, v57
    v_fma_f32 v54, v38, s43, v57
    v_fma_f32 v55, v39, s43, v57
    v_exp_f32 v40, v40
    v_exp_f32 v41, v41
    v_exp_f32 v42, v42
    v_exp_f32 v43, v43
    v_exp_f32 v44, v44
    v_exp_f32 v45, v45
    v_exp_f32 v46, v46
    v_exp_f32 v47, v47
    v_exp_f32 v48, v48
    v_exp_f32 v49, v49
    v_exp_f32 v50, v50
    v_exp_f32 v51, v51
    v_exp_f32 v52, v52
    v_exp_f32 v53, v53
    v_exp_f32 v54, v54
    v_exp_f32 v55, v55
    v_cndmask_b32_e64 v52, v52, 0, s[44:45]
    v_cndmask_b32_e64 v53, v53, 0, s[44:45]
    v_cndmask_b32_e64 v54, v54, 0, s[44:45]
    v_cndmask_b32_e64 v55, v55, 0, s[44:45]
    v_pk_add_f32 v[60:61], v[40:41], v[42:43]
    v_pk_add_f32 v[62:63], v[44:45], v[46:47]
    v_pk_add_f32 v[60:61], v[60:61], v[48:49]
    v_pk_add_f32 v[62:63], v[62:63], v[50:51]
    v_pk_add_f32 v[60:61], v[60:61], v[52:53]
    v_pk_add_f32 v[62:63], v[62:63], v[54:55]
    v_pk_add_f32 v[60:61], v[60:61], v[62:63]
    v_add_f32 v60, v60, v61
    v_mov_b32 v61, v60
    s_nop 1
    v_permlane32_swap_b32 v60, v61
    v_add_f32 v60, v60, v61
    v_rcp_f32 v60, v60
    s_nop 0
    v_pk_mul_f32 v[40:41], v[40:41], v[60:61] op_sel_hi:[1,0]
    v_pk_mul_f32 v[42:43], v[42:43], v[60:61] op_sel_hi:[1,0]
    v_pk_mul_f32 v[44:45], v[44:45], v[60:61] op_sel_hi:[1,0]
    v_pk_mul_f32 v[46:47], v[46:47], v[60:61] op_sel_hi:[1,0]
    v_pk_mul_f32 v[48:49], v[48:49], v[60:61] op_sel_hi:[1,0]
    v_pk_mul_f32 v[50:51], v[50:51], v[60:61] op_sel_hi:[1,0]
    v_pk_mul_f32 v[52:53], v[52:53], v[60:61] op_sel_hi:[1,0]
    v_pk_mul_f32 v[54:55], v[54:55], v[60:61] op_sel_hi:[1,0]
    v_cvt_pk_bf16_f32 v40, v40, v41
    v_cvt_pk_bf16_f32 v41, v42, v43
    v_cvt_pk_bf16_f32 v42, v44, v45
    v_cvt_pk_bf16_f32 v43, v46, v47
    v_cvt_pk_bf16_f32 v44, v48, v49
    v_cvt_pk_bf16_f32 v45, v50, v51
    v_cvt_pk_bf16_f32 v46, v52, v53
    v_cvt_pk_bf16_f32 v47, v54, v55
    v_mov_b32 v136, v40
    v_mov_b32 v137, v41
    v_mov_b32 v138, v42
    v_mov_b32 v139, v43
    v_mov_b32 v140, v44
    v_mov_b32 v141, v45
    v_mov_b32 v142, v46
    v_mov_b32 v143, v47
    s_waitcnt vmcnt(14)
    v_mfma_f32_16x16x32_bf16 v[24:27], v[8:11], v[64:67], 0
    v_mfma_f32_16x16x32_bf16 v[28:31], v[8:11], v[68:71], 0
    s_waitcnt vmcnt(12)
    v_mfma_f32_16x16x32_bf16 v[24:27], v[8:11], v[72:75], v[24:27]
    v_mfma_f32_16x16x32_bf16 v[28:31], v[8:11], v[76:79], v[28:31]
    s_waitcnt vmcnt(10)
    v_mfma_f32_16x16x32_bf16 v[24:27], v[8:11], v[80:83], v[24:27]
    v_mfma_f32_16x16x32_bf16 v[28:31], v[8:11], v[84:87], v[28:31]
    s_waitcnt vmcnt(8)
    v_mfma_f32_16x16x32_bf16 v[24:27], v[8:11], v[88:91], v[24:27]
    v_mfma_f32_16x16x32_bf16 v[28:31], v[8:11], v[92:95], v[28:31]
    s_waitcnt vmcnt(6)
    v_mfma_f32_16x16x32_bf16 v[24:27], v[8:11], v[96:99], v[24:27]
    v_mfma_f32_16x16x32_bf16 v[28:31], v[8:11], v[100:103], v[28:31]
    s_waitcnt vmcnt(4)
    v_mfma_f32_16x16x32_bf16 v[24:27], v[8:11], v[104:107], v[24:27]
    v_mfma_f32_16x16x32_bf16 v[28:31], v[8:11], v[108:111], v[28:31]
    s_waitcnt vmcnt(2)
    v_mfma_f32_16x16x32_bf16 v[24:27], v[8:11], v[112:115], v[24:27]
    v_mfma_f32_16x16x32_bf16 v[28:31], v[8:11], v[116:119], v[28:31]
    s_waitcnt vmcnt(0)
    v_mfma_f32_16x16x32_bf16 v[24:27], v[8:11], v[120:123], v[24:27]
    v_mfma_f32_16x16x32_bf16 v[28:31], v[8:11], v[124:127], v[28:31]
    s_nop 6
    v_cvt_pk_bf16_f32 v40, v24, v25
    v_cvt_pk_bf16_f32 v41, v26, v27
    v_cvt_pk_bf16_f32 v42, v28, v29
    v_cvt_pk_bf16_f32 v43, v30, v31
    ds_write_b128 v7, v[40:43]
    v_lshlrev_b32 v12, 4, v1
    s_waitcnt lgkmcnt(0)
    s_barrier
    ds_read_b128 v[64:67], v12 offset:0
    ds_read_b128 v[68:71], v12 offset:1024
    ds_read_b128 v[72:75], v12 offset:2048
    ds_read_b128 v[76:79], v12 offset:3072
    s_waitcnt lgkmcnt(3)
    v_mfma_f32_32x32x16_bf16 v[24:39], v[64:67], v[128:131], 0
    s_waitcnt lgkmcnt(2)
    v_mfma_f32_32x32x16_bf16 v[24:39], v[68:71], v[132:135], v[24:39]
    s_waitcnt lgkmcnt(1)
    v_mfma_f32_32x32x16_bf16 v[24:39], v[72:75], v[136:139], v[24:39]
    s_waitcnt lgkmcnt(0)
    v_mfma_f32_32x32x16_bf16 v[24:39], v[76:79], v[140:143], v[24:39]
    s_nop 7
    s_nop 3
    v_mov_b32 v40, v36
    v_mov_b32 v41, v36
    s_nop 1
    v_permlane32_swap_b32 v40, v41
    v_add_f32 v41, 0x358637bd, v41
    v_rcp_f32 v41, v41
    s_nop 0
    v_mul_f32 v24, v24, v41
    v_mul_f32 v25, v25, v41
    v_mul_f32 v26, v26, v41
    v_mul_f32 v27, v27, v41
    v_mul_f32 v28, v28, v41
    v_mul_f32 v29, v29, v41
    v_mul_f32 v30, v30, v41
    v_mul_f32 v31, v31, v41
    v_mul_f32 v32, v32, v41
    v_mul_f32 v33, v33, v41
    v_mul_f32 v34, v34, v41
    v_mul_f32 v35, v35, v41
    v_mul_f32 v36, v36, v41
    v_mul_f32 v37, v37, v41
    v_mul_f32 v38, v38, v41
    v_mul_f32 v39, v39, v41
    v_cvt_pk_bf16_f32 v44, v24, v25
    v_cvt_pk_bf16_f32 v45, v26, v27
    v_cvt_pk_bf16_f32 v48, v28, v29
    v_cvt_pk_bf16_f32 v49, v30, v31
    v_cvt_pk_bf16_f32 v46, v32, v33
    v_cvt_pk_bf16_f32 v47, v34, v35
    v_cvt_pk_bf16_f32 v50, v36, v37
    v_cvt_pk_bf16_f32 v51, v38, v39
    v_cmp_gt_u32 vcc, 32, v1
    s_nop 1
    v_cndmask_b32 v50, 0, v50, vcc
    v_cndmask_b32 v51, 0, v51, vcc
    v_permlane32_swap_b32 v44, v46
    v_permlane32_swap_b32 v45, v47
    v_permlane32_swap_b32 v48, v50
    v_permlane32_swap_b32 v49, v51
    buffer_store_dwordx4 v[44:47], v6, s[24:27], 0 offen sc1
    buffer_store_dwordx4 v[48:51], v6, s[24:27], 0 offen offset:1024 sc1
    s_and_b32 s42, s12, 1
    s_lshr_b32 s43, s12, 1
    v_bfe_u32 v13, v1, 4, 1
    v_bfe_u32 v14, v1, 2, 2
    v_and_b32 v15, 3, v1
    v_lshrrev_b32 v16, 1, v15
    v_lshl_add_u32 v16, v13, 1, v16
    v_lshrrev_b32 v17, 1, v14
    v_lshlrev_b32 v17, 2, v17
    v_xor_b32 v16, v16, v17
    v_lshl_add_u32 v17, v3, 4, v14
    v_lshlrev_b32 v17, 7, v17
    v_lshl_add_u32 v17, v16, 4, v17
    v_and_b32 v15, 1, v15
    v_lshl_add_u32 v17, v15, 3, v17
    s_mul_i32 s36, s43, 28672
    s_add_u32 s36, s36, 4096
    v_add_u32 v17, s36, v17
    s_lshl_b32 s36, s43, 6
    v_xor_b32 v4, s36, v17
    v_xor_b32 v5, 64, v4
    s_lshl_b32 s36, s38, 1
    s_add_u32 s36, s36, s42
    s_lshl_b32 s36, s36, 11
    s_lshl_b32 s37, s43, 16
    s_add_u32 s36, s36, s37
    v_lshlrev_b32 v13, 4, v1
    v_add_u32 v7, s36, v13
    s_mov_b32 s49, 8192
    s_mov_b32 s50, 16384
    s_mov_b32 s51, 24576
    s_mov_b32 s52, 32768
    s_mov_b32 s53, 40960
    s_mov_b32 s54, 49152
    s_mov_b32 s55, 57344
    s_lshl_b32 s36, s12, 12
    s_add_u32 s36, s36, 4096
    v_add_u32 v8, s36, v13
    s_xor_b32 s36, s12, 2
    s_lshl_b32 s36, s36, 12
    s_add_u32 s36, s36, 4096
    v_add_u32 v9, s36, v13
    s_lshl_b32 s36, s42, 5
    v_add_u32 v13, s36, v2
    v_mul_u32_u24 v13, 144, v13
    v_lshl_add_u32 v13, v3, 3, v13
    s_lshl_b32 s36, s43, 6
    s_add_u32 s36, s36, 20480
    v_add_u32 v10, s36, v13
    v_lshrrev_b32 v13, 3, v0
    v_and_b32 v14, 7, v0
    v_mul_u32_u24 v15, 144, v13
    v_lshl_add_u32 v11, v14, 4, v15
    v_add_u32 v11, 20480, v11
    v_mul_u32_u24 v15, 1792, v13
    v_lshl_add_u32 v12, v14, 4, v15
    s_waitcnt vmcnt(0)
    s_barrier
    s_cmp_eq_u32 s12, 0
    s_cbranch_scc0 hh_k4_kernel_a2_nosig
    s_mov_b64 exec, 0xff
    v_mov_b32 v14, 1
    v_lshlrev_b32 v13, 7, v1
    buffer_atomic_add v14, v13, s[32:35], 0 offen sc1
    s_mov_b64 exec, -1
hh_k4_kernel_a2_nosig:
    s_cmp_eq_u32 s15, 7
    s_cbranch_scc1 hh_k4_kernel_a2_done
    ds_read_b64_tr_b16 v[64:65], v4 offset:0
    ds_read_b64_tr_b16 v[66:67], v4 offset:512
    ds_read_b64_tr_b16 v[68:69], v5 offset:0
    ds_read_b64_tr_b16 v[70:71], v5 offset:512
    ds_read_b64_tr_b16 v[72:73], v4 offset:1024
    ds_read_b64_tr_b16 v[74:75], v4 offset:1536
    ds_read_b64_tr_b16 v[76:77], v5 offset:1024
    ds_read_b64_tr_b16 v[78:79], v5 offset:1536
    s_waitcnt lgkmcnt(6)
    ds_read_b64_tr_b16 v[80:81], v4 offset:3584
    ds_read_b64_tr_b16 v[82:83], v4 offset:4096
    ds_read_b64_tr_b16 v[84:85], v5 offset:3584
    ds_read_b64_tr_b16 v[86:87], v5 offset:4096
    ds_read_b64_tr_b16 v[88:89], v4 offset:4608
    ds_read_b64_tr_b16 v[90:91], v4 offset:5120
    ds_read_b64_tr_b16 v[92:93], v5 offset:4608
    ds_read_b64_tr_b16 v[94:95], v5 offset:5120
    s_waitcnt lgkmcnt(6)
    ds_read_b64_tr_b16 v[96:97], v4 offset:7168
    ds_read_b64_tr_b16 v[98:99], v4 offset:7680
    ds_read_b64_tr_b16 v[100:101], v5 offset:7168
    ds_read_b64_tr_b16 v[102:103], v5 offset:7680
    ds_read_b64_tr_b16 v[104:105], v4 offset:8192
    ds_read_b64_tr_b16 v[106:107], v4 offset:8704
    ds_read_b64_tr_b16 v[108:109], v5 offset:8192
    ds_read_b64_tr_b16 v[110:111], v5 offset:8704
    s_waitcnt lgkmcnt(6)
    ds_read_b64_tr_b16 v[112:113], v4 offset:10752
    ds_read_b64_tr_b16 v[114:115], v4 offset:11264
    ds_read_b64_tr_b16 v[116:117], v5 offset:10752
    ds_read_b64_tr_b16 v[118:119], v5 offset:11264
    ds_read_b64_tr_b16 v[120:121], v4 offset:11776
    ds_read_b64_tr_b16 v[122:123], v4 offset:12288
    ds_read_b64_tr_b16 v[124:125], v5 offset:11776
    ds_read_b64_tr_b16 v[126:127], v5 offset:12288
    s_waitcnt lgkmcnt(6)
    ds_read_b64_tr_b16 v[128:129], v4 offset:14336
    ds_read_b64_tr_b16 v[130:131], v4 offset:14848
    ds_read_b64_tr_b16 v[132:133], v5 offset:14336
    ds_read_b64_tr_b16 v[134:135], v5 offset:14848
    ds_read_b64_tr_b16 v[136:137], v4 offset:15360
    ds_read_b64_tr_b16 v[138:139], v4 offset:15872
    ds_read_b64_tr_b16 v[140:141], v5 offset:15360
    ds_read_b64_tr_b16 v[142:143], v5 offset:15872
    s_waitcnt lgkmcnt(6)
    ds_read_b64_tr_b16 v[144:145], v4 offset:17920
    ds_read_b64_tr_b16 v[146:147], v4 offset:18432
    ds_read_b64_tr_b16 v[148:149], v5 offset:17920
    ds_read_b64_tr_b16 v[150:151], v5 offset:18432
    ds_read_b64_tr_b16 v[152:153], v4 offset:18944
    ds_read_b64_tr_b16 v[154:155], v4 offset:19456
    ds_read_b64_tr_b16 v[156:157], v5 offset:18944
    ds_read_b64_tr_b16 v[158:159], v5 offset:19456
    s_waitcnt lgkmcnt(6)
    ds_read_b64_tr_b16 v[160:161], v4 offset:21504
    ds_read_b64_tr_b16 v[162:163], v4 offset:22016
    ds_read_b64_tr_b16 v[164:165], v5 offset:21504
    ds_read_b64_tr_b16 v[166:167], v5 offset:22016
    ds_read_b64_tr_b16 v[168:169], v4 offset:22528
    ds_read_b64_tr_b16 v[170:171], v4 offset:23040
    ds_read_b64_tr_b16 v[172:173], v5 offset:22528
    ds_read_b64_tr_b16 v[174:175], v5 offset:23040
    s_waitcnt lgkmcnt(6)
    ds_read_b64_tr_b16 v[176:177], v4 offset:25088
    ds_read_b64_tr_b16 v[178:179], v4 offset:25600
    ds_read_b64_tr_b16 v[180:181], v5 offset:25088
    ds_read_b64_tr_b16 v[182:183], v5 offset:25600
    ds_read_b64_tr_b16 v[184:185], v4 offset:26112
    ds_read_b64_tr_b16 v[186:187], v4 offset:26624
    ds_read_b64_tr_b16 v[188:189], v5 offset:26112
    ds_read_b64_tr_b16 v[190:191], v5 offset:26624
    s_cmp_eq_u32 s12, 0
    s_cbranch_scc0 hh_k4_kernel_a2_nopoll
    s_mov_b64 exec, 1
    s_and_b32 s37, s2, 7
    s_lshl_b32 s37, s37, 7
    v_mov_b32 v13, s37
    s_mov_b32 s36, 0x100000
hh_k4_kernel_a2_poll:
    buffer_load_dword v14, v13, s[32:35], 0 offen sc1
    s_waitcnt vmcnt(0)
    v_readfirstlane_b32 s37, v14
    s_cmp_ge_u32 s37, 16
    s_cbranch_scc1 hh_k4_kernel_a2_poll_ok
    s_sub_u32 s36, s36, 1
    s_cmp_lg_u32 s36, 0
    s_cbranch_scc1 hh_k4_kernel_a2_poll
hh_k4_kernel_a2_poll_ok:
    s_mov_b64 exec, -1
hh_k4_kernel_a2_nopoll:
    s_waitcnt lgkmcnt(0)
    s_barrier
    buffer_load_dwordx4 v[192:195], v7, s[16:19], 0 offen sc1
    buffer_load_dwordx4 v[196:199], v7, s[16:19], 0 offen offset:1024 sc1
    buffer_load_dwordx4 v[200:203], v7, s[16:19], s49 offen sc1
    buffer_load_dwordx4 v[204:207], v7, s[16:19], s49 offen offset:1024 sc1
    buffer_load_dwordx4 v[208:211], v7, s[16:19], s50 offen sc1
    buffer_load_dwordx4 v[212:215], v7, s[16:19], s50 offen offset:1024 sc1
    buffer_load_dwordx4 v[216:219], v7, s[16:19], s51 offen sc1
    buffer_load_dwordx4 v[220:223], v7, s[16:19], s51 offen offset:1024 sc1
    buffer_load_dwordx4 v[224:227], v7, s[16:19], s52 offen sc1
    buffer_load_dwordx4 v[228:231], v7, s[16:19], s52 offen offset:1024 sc1
    buffer_load_dwordx4 v[232:235], v7, s[16:19], s53 offen sc1
    buffer_load_dwordx4 v[236:239], v7, s[16:19], s53 offen offset:1024 sc1
    buffer_load_dwordx4 v[240:243], v7, s[16:19], s54 offen sc1
    buffer_load_dwordx4 v[244:247], v7, s[16:19], s54 offen offset:1024 sc1
    buffer_load_dwordx4 v[248:251], v7, s[16:19], s55 offen sc1
    buffer_load_dwordx4 v[252:255], v7, s[16:19], s55 offen offset:1024 sc1
    s_waitcnt vmcnt(15)
    v_mfma_f32_32x32x16_bf16 v[24:39], v[64:67], v[192:195], 0
    v_mfma_f32_32x32x16_bf16 v[40:55], v[68:71], v[192:195], 0
    s_waitcnt vmcnt(14)
    v_mfma_f32_32x32x16_bf16 v[24:39], v[72:75], v[196:199], v[24:39]
    v_mfma_f32_32x32x16_bf16 v[40:55], v[76:79], v[196:199], v[40:55]
    s_waitcnt vmcnt(13)
    v_mfma_f32_32x32x16_bf16 v[24:39], v[80:83], v[200:203], v[24:39]
    v_mfma_f32_32x32x16_bf16 v[40:55], v[84:87], v[200:203], v[40:55]
    s_waitcnt vmcnt(12)
    v_mfma_f32_32x32x16_bf16 v[24:39], v[88:91], v[204:207], v[24:39]
    v_mfma_f32_32x32x16_bf16 v[40:55], v[92:95], v[204:207], v[40:55]
    s_waitcnt vmcnt(11)
    v_mfma_f32_32x32x16_bf16 v[24:39], v[96:99], v[208:211], v[24:39]
    v_mfma_f32_32x32x16_bf16 v[40:55], v[100:103], v[208:211], v[40:55]
    s_waitcnt vmcnt(10)
    v_mfma_f32_32x32x16_bf16 v[24:39], v[104:107], v[212:215], v[24:39]
    v_mfma_f32_32x32x16_bf16 v[40:55], v[108:111], v[212:215], v[40:55]
    s_waitcnt vmcnt(9)
    v_mfma_f32_32x32x16_bf16 v[24:39], v[112:115], v[216:219], v[24:39]
    v_mfma_f32_32x32x16_bf16 v[40:55], v[116:119], v[216:219], v[40:55]
    s_waitcnt vmcnt(8)
    v_mfma_f32_32x32x16_bf16 v[24:39], v[120:123], v[220:223], v[24:39]
    v_mfma_f32_32x32x16_bf16 v[40:55], v[124:127], v[220:223], v[40:55]
    s_waitcnt vmcnt(7)
    v_mfma_f32_32x32x16_bf16 v[24:39], v[128:131], v[224:227], v[24:39]
    v_mfma_f32_32x32x16_bf16 v[40:55], v[132:135], v[224:227], v[40:55]
    s_waitcnt vmcnt(6)
    v_mfma_f32_32x32x16_bf16 v[24:39], v[136:139], v[228:231], v[24:39]
    v_mfma_f32_32x32x16_bf16 v[40:55], v[140:143], v[228:231], v[40:55]
    s_waitcnt vmcnt(5)
    v_mfma_f32_32x32x16_bf16 v[24:39], v[144:147], v[232:235], v[24:39]
    v_mfma_f32_32x32x16_bf16 v[40:55], v[148:151], v[232:235], v[40:55]
    s_waitcnt vmcnt(4)
    v_mfma_f32_32x32x16_bf16 v[24:39], v[152:155], v[236:239], v[24:39]
    v_mfma_f32_32x32x16_bf16 v[40:55], v[156:159], v[236:239], v[40:55]
    s_waitcnt vmcnt(3)
    v_mfma_f32_32x32x16_bf16 v[24:39], v[160:163], v[240:243], v[24:39]
    v_mfma_f32_32x32x16_bf16 v[40:55], v[164:167], v[240:243], v[40:55]
    s_waitcnt vmcnt(2)
    v_mfma_f32_32x32x16_bf16 v[24:39], v[168:171], v[244:247], v[24:39]
    v_mfma_f32_32x32x16_bf16 v[40:55], v[172:175], v[244:247], v[40:55]
    s_waitcnt vmcnt(1)
    v_mfma_f32_32x32x16_bf16 v[24:39], v[176:179], v[248:251], v[24:39]
    v_mfma_f32_32x32x16_bf16 v[40:55], v[180:183], v[248:251], v[40:55]
    s_waitcnt vmcnt(0)
    v_mfma_f32_32x32x16_bf16 v[24:39], v[184:187], v[252:255], v[24:39]
    v_mfma_f32_32x32x16_bf16 v[40:55], v[188:191], v[252:255], v[40:55]
    s_nop 7
    s_nop 3
    ds_write_b128 v8, v[40:43] offset:0
    ds_write_b128 v8, v[44:47] offset:1024
    ds_write_b128 v8, v[48:51] offset:2048
    ds_write_b128 v8, v[52:55] offset:3072
    s_waitcnt lgkmcnt(0)
    s_barrier
    ds_read_b128 v[64:67], v9 offset:0
    ds_read_b128 v[68:71], v9 offset:1024
    ds_read_b128 v[72:75], v9 offset:2048
    ds_read_b128 v[76:79], v9 offset:3072
    s_waitcnt lgkmcnt(3)
    v_add_f32 v24, v24, v64
    v_add_f32 v25, v25, v65
    v_add_f32 v26, v26, v66
    v_add_f32 v27, v27, v67
    v_cvt_pk_bf16_f32 v80, v24, v25
    v_cvt_pk_bf16_f32 v81, v26, v27
    ds_write_b64 v10, v[80:81] offset:0
    s_waitcnt lgkmcnt(2)
    v_add_f32 v28, v28, v68
    v_add_f32 v29, v29, v69
    v_add_f32 v30, v30, v70
    v_add_f32 v31, v31, v71
    v_cvt_pk_bf16_f32 v82, v28, v29
    v_cvt_pk_bf16_f32 v83, v30, v31
    ds_write_b64 v10, v[82:83] offset:16
    s_waitcnt lgkmcnt(1)
    v_add_f32 v32, v32, v72
    v_add_f32 v33, v33, v73
    v_add_f32 v34, v34, v74
    v_add_f32 v35, v35, v75
    v_cvt_pk_bf16_f32 v84, v32, v33
    v_cvt_pk_bf16_f32 v85, v34, v35
    ds_write_b64 v10, v[84:85] offset:32
    s_waitcnt lgkmcnt(0)
    v_add_f32 v36, v36, v76
    v_add_f32 v37, v37, v77
    v_add_f32 v38, v38, v78
    v_add_f32 v39, v39, v79
    v_cvt_pk_bf16_f32 v86, v36, v37
    v_cvt_pk_bf16_f32 v87, v38, v39
    ds_write_b64 v10, v[86:87] offset:48
    s_waitcnt lgkmcnt(0)
    s_barrier
    ds_read_b128 v[96:99], v11 offset:0
    ds_read_b128 v[100:103], v11 offset:4608
    v_add_u32 v3, 57344, v12
    s_waitcnt lgkmcnt(1)
    buffer_store_dwordx4 v[96:99], v12, s[20:23], 0 offen
    s_waitcnt lgkmcnt(0)
    buffer_store_dwordx4 v[100:103], v3, s[20:23], 0 offen
hh_k4_kernel_a2_done:
    s_endpgm
hh_k4_kernel_b1:
    s_load_dwordx8 s[8:15], s[0:1], 40
    s_load_dwordx4 s[16:19], s[0:1], 72
    s_load_dwordx4 s[20:23], s[0:1], 88
    s_load_dwordx2 s[52:53], s[0:1], 32
    s_load_dwordx2 s[24:25], s[0:1], 120
    s_sub_u32 s26, s2, 256
    s_setprio 3
    v_lshrrev_b32 v2, 6, v0
    v_and_b32 v1, 63, v0
    v_readfirstlane_b32 s27, v2
    s_lshl_b32 s30, s26, 10
    v_lshlrev_b32 v2, 2, v0
    v_add_u32 v2, s30, v2
    s_lshr_b32 s28, s27, 1
    s_and_b32 s29, s27, 1
    s_lshl_b32 s31, s26, 2
    s_mul_i32 s32, s26, 293
    s_lshr_b32 s32, s32, 11
    s_mul_i32 s30, s32, 7
    s_sub_u32 s33, s26, s30
    v_lshrrev_b32 v3, 3, v1
    s_lshl_b32 s30, s27, 4
    v_add_u32 v3, s30, v3
    v_mul_u32_u24 v3, 896, v3
    v_bfe_u32 v4, v1, 4, 1
    v_lshlrev_b32 v4, 2, v4
    v_and_b32 v5, 7, v1
    v_xor_b32 v4, v4, v5
    v_lshl_add_u32 v8, v4, 4, v3
    v_add_u32 v9, 7168, v8
    s_waitcnt lgkmcnt(0)
    global_load_dword v10, v2, s[8:9]
    global_load_dword v11, v2, s[10:11]
    global_load_dword v12, v2, s[12:13]
    global_load_dword v13, v2, s[14:15]
    global_load_dword v14, v2, s[16:17]
    global_load_dword v15, v2, s[18:19]
    s_load_dword s34, s[20:21], s31
    s_load_dword s35, s[22:23], s31
    s_mul_i32 s30, s32, 57344
    s_lshl_b32 s31, s33, 7
    s_add_u32 s30, s30, s31
    s_add_u32 s36, s52, s30
    s_addc_u32 s37, s53, 0
    s_mov_b32 s38, 56576
    s_mov_b32 s39, 0x00020000
    s_lshl_b32 s30, s27, 11
    s_add_u32 m0, s30, 65536
    s_add_u32 s30, s30, 66560
    buffer_load_dwordx4 v8, s[36:39], 0 offen lds
    s_mov_b32 m0, s30
    s_lshl_b32 s30, s33, 18
    buffer_load_dwordx4 v9, s[36:39], 0 offen lds
    s_lshl_b32 s31, s32, 7
    s_add_u32 s30, s30, s31
    s_add_u32 s30, s30, 9437184
    s_add_u32 s40, s24, s30
    s_addc_u32 s41, s25, 0
    s_mov_b32 s42, 258176
    s_mov_b32 s43, 0x00020000
    s_lshl_b32 s30, s26, 1
    s_add_u32 s30, s30, s28
    s_mul_i32 s30, s30, 8320
    s_add_u32 s30, s30, 5242880
    s_add_u32 s44, s24, s30
    s_addc_u32 s45, s25, 0
    s_mov_b32 s46, 8320
    s_mov_b32 s47, 0x00020000
    s_or_b32 s30, s26, s27
    s_cmp_eq_u32 s30, 0
    s_cbranch_scc0 hh_k4_kernel_b1clr
    s_add_u32 s4, s24, 14680064
    s_addc_u32 s5, s25, 0
    s_mov_b32 s6, 65536
    s_mov_b32 s7, 0x00020000
    v_lshlrev_b32 v3, 7, v1
    v_mov_b32 v4, 0
    s_mov_b32 s30, 0
    buffer_store_dword v4, v3, s[4:7], s30 offen sc1
    s_mov_b32 s30, 8192
    buffer_store_dword v4, v3, s[4:7], s30 offen sc1
    s_mov_b32 s30, 16384
    buffer_store_dword v4, v3, s[4:7], s30 offen sc1
    s_mov_b32 s30, 24576
    buffer_store_dword v4, v3, s[4:7], s30 offen sc1
    s_mov_b32 s30, 32768
    buffer_store_dword v4, v3, s[4:7], s30 offen sc1
    s_mov_b32 s30, 40960
    buffer_store_dword v4, v3, s[4:7], s30 offen sc1
    s_mov_b32 s30, 49152
    buffer_store_dword v4, v3, s[4:7], s30 offen sc1
    s_mov_b32 s30, 57344
    buffer_store_dword v4, v3, s[4:7], s30 offen sc1
    s_waitcnt vmcnt(0)
    s_mov_b32 s4, s54
    s_mov_b32 s5, s55
    s_mov_b32 s6, 4
    v_mov_b32 v3, 0
    v_mov_b32 v4, 1
    s_mov_b64 exec, 1
    buffer_store_dword v4, v3, s[4:7], 0 offen sc1
    s_waitcnt vmcnt(0)
    s_mov_b64 exec, -1
hh_k4_kernel_b1clr:
    s_setprio 0
    s_lshl_b32 s48, s27, 14
    s_lshl_b32 s49, s28, 15
    s_add_u32 s49, s49, 2048
    v_bfe_u32 v3, v1, 1, 2
    v_lshl_add_u32 v4, v1, 6, s48
    v_xor_b32 v5, 0, v3
    v_lshl_add_u32 v16, v5, 4, v4
    v_xor_b32 v5, 1, v3
    v_lshl_add_u32 v17, v5, 4, v4
    v_xor_b32 v5, 2, v3
    v_lshl_add_u32 v18, v5, 4, v4
    v_xor_b32 v5, 3, v3
    v_lshl_add_u32 v19, v5, 4, v4
    v_lshrrev_b32 v3, 5, v1
    v_bfe_u32 v4, v1, 2, 2
    v_lshl_add_u32 v3, v3, 3, v4
    v_lshl_add_u32 v3, v3, 6, s48
    v_bfe_u32 v5, v1, 4, 1
    v_bfe_u32 v6, v1, 1, 1
    v_lshl_add_u32 v5, v5, 1, v6
    v_lshrrev_b32 v4, 1, v4
    v_xor_b32 v5, v5, v4
    v_and_b32 v6, 1, v1
    v_lshl_add_u32 v3, v6, 3, v3
    v_lshl_add_u32 v20, v5, 4, v3
    v_xor_b32 v5, 2, v5
    v_lshl_add_u32 v3, v5, 4, v3
    v_add_u32 v21, 256, v3
    s_lshl_b32 s30, s29, 6
    v_add_u32 v3, s30, v1
    v_lshlrev_b32 v3, 4, v3
    v_sub_u32 v3, 4096, v3
    v_cvt_f32_u32 v3, v3
    v_mov_b32 v22, v3
    v_add_f32 v23, 0xc0000000, v3
    v_add_f32 v24, 0xc0800000, v3
    v_add_f32 v25, 0xc0c00000, v3
    v_add_f32 v26, 0xc1000000, v3
    v_add_f32 v27, 0xc1200000, v3
    v_add_f32 v28, 0xc1400000, v3
    v_add_f32 v29, 0xc1600000, v3
    v_add_f32 v30, 0xc1800000, v3
    v_add_f32 v31, 0xc5000000, v3
    v_add_f32 v32, 0xc5002000, v3
    v_add_f32 v33, 0xc5004000, v3
    v_add_f32 v34, 0xc5006000, v3
    v_add_f32 v35, 0xc5008000, v3
    v_add_f32 v36, 0xc500a000, v3
    v_add_f32 v37, 0xc500c000, v3
    v_add_f32 v38, 0xc500e000, v3
    v_add_f32 v39, 0xc5010000, v3
    v_cvt_pk_bf16_f32 v4, v22, v23
    v_lshlrev_b32 v22, 16, v4
    v_and_b32 v23, 0xffff0000, v4
    v_cvt_pk_bf16_f32 v4, v24, v25
    v_lshlrev_b32 v24, 16, v4
    v_and_b32 v25, 0xffff0000, v4
    v_cvt_pk_bf16_f32 v4, v26, v27
    v_lshlrev_b32 v26, 16, v4
    v_and_b32 v27, 0xffff0000, v4
    v_cvt_pk_bf16_f32 v4, v28, v29
    v_lshlrev_b32 v28, 16, v4
    v_and_b32 v29, 0xffff0000, v4
    v_cvt_pk_bf16_f32 v4, v30, v31
    v_lshlrev_b32 v30, 16, v4
    v_and_b32 v31, 0xffff0000, v4
    v_cvt_pk_bf16_f32 v4, v32, v33
    v_lshlrev_b32 v32, 16, v4
    v_and_b32 v33, 0xffff0000, v4
    v_cvt_pk_bf16_f32 v4, v34, v35
    v_lshlrev_b32 v34, 16, v4
    v_and_b32 v35, 0xffff0000, v4
    v_cvt_pk_bf16_f32 v4, v36, v37
    v_lshlrev_b32 v36, 16, v4
    v_and_b32 v37, 0xffff0000, v4
    v_cvt_pk_bf16_f32 v4, v38, v39
    v_lshlrev_b32 v38, 16, v4
    v_and_b32 v39, 0xffff0000, v4
    v_cvt_u32_f32 v22, v22
    v_cvt_u32_f32 v23, v23
    v_cvt_u32_f32 v24, v24
    v_cvt_u32_f32 v25, v25
    v_cvt_u32_f32 v26, v26
    v_cvt_u32_f32 v27, v27
    v_cvt_u32_f32 v28, v28
    v_cvt_u32_f32 v29, v29
    v_cvt_u32_f32 v30, v30
    v_cvt_u32_f32 v31, v31
    v_cvt_u32_f32 v32, v32
    v_cvt_u32_f32 v33, v33
    v_cvt_u32_f32 v34, v34
    v_cvt_u32_f32 v35, v35
    v_cvt_u32_f32 v36, v36
    v_cvt_u32_f32 v37, v37
    v_cvt_u32_f32 v38, v38
    v_cvt_u32_f32 v39, v39
    v_add_u32 v22, s49, v22
    v_add_u32 v23, s49, v23
    v_add_u32 v24, s49, v24
    v_add_u32 v25, s49, v25
    v_add_u32 v26, s49, v26
    v_add_u32 v27, s49, v27
    v_add_u32 v28, s49, v28
    v_add_u32 v29, s49, v29
    v_add_u32 v30, s49, v30
    v_add_u32 v31, s49, v31
    v_add_u32 v32, s49, v32
    v_add_u32 v33, s49, v33
    v_add_u32 v34, s49, v34
    v_add_u32 v35, s49, v35
    v_add_u32 v36, s49, v36
    v_add_u32 v37, s49, v37
    v_add_u32 v38, s49, v38
    v_add_u32 v39, s49, v39
    v_lshrrev_b32 v3, 4, v1
    v_bfe_u32 v4, v1, 2, 2
    v_lshl_add_u32 v5, v3, 3, v4
    v_lshlrev_b32 v5, 7, v5
    v_bfe_u32 v6, v1, 1, 1
    s_lshl_b32 s30, s27, 1
    v_add_u32 v6, s30, v6
    v_lshrrev_b32 v4, 1, v4
    v_lshlrev_b32 v4, 2, v4
    v_xor_b32 v6, v6, v4
    v_lshl_add_u32 v5, v6, 4, v5
    v_and_b32 v6, 1, v1
    v_lshl_add_u32 v5, v6, 3, v5
    v_add_u32 v40, 65536, v5
    v_and_b32 v4, 15, v1
    s_lshl_b32 s30, s27, 4
    v_add_u32 v4, s30, v4
    v_lshlrev_b32 v4, 12, v4
    v_lshl_add_u32 v41, v3, 4, v4
    v_lshlrev_b32 v3, 4, v1
    v_add_u32 v42, s48, v3
    s_xor_b32 s30, s48, 16384
    v_add_u32 v43, s30, v3
    v_and_b32 v4, 31, v1
    v_lshrrev_b32 v5, 5, v1
    s_mul_i32 s30, s29, 6
    s_add_u32 s30, s30, 3
    v_lshlrev_b32 v5, s30, v5
    v_lshl_add_u32 v4, v4, 4, v5
    v_add_u32 v44, s49, v4
    s_lshl_b32 s30, s29, 10
    v_add_u32 v45, s30, v3
    s_waitcnt lgkmcnt(0)
    s_lshl_b32 s30, s28, 4
    s_lshr_b32 s34, s34, s30
    s_lshl_b32 s34, s34, 16
    s_lshr_b32 s35, s35, s30
    s_lshl_b32 s35, s35, 16
    v_mov_b32 v47, s35
    v_cmp_eq_u32 vcc, 0, v1
    s_nop 1
    v_cndmask_b32 v47, 0, v47, vcc
    s_mov_b32 s50, 0x3fb8aa3b
    s_mov_b32 s51, 0x32a57060
    v_mov_b32 v3, s34
    v_mul_f32 v4, s50, v3
    v_fma_f32 v5, v3, s50, -v4
    v_fma_f32 v5, v3, s51, v5
    v_exp_f32 v4, v4
    v_mul_f32 v5, 0x3f317218, v5
    v_fma_f32 v4, v4, v5, v4
    v_cvt_pk_bf16_f32 v4, v4, v4
    v_lshlrev_b32 v46, 16, v4
    s_waitcnt vmcnt(2)
    v_lshlrev_b32 v58, 16, v10
    v_lshlrev_b32 v59, 16, v11
    v_lshlrev_b32 v60, 16, v12
    v_lshlrev_b32 v61, 16, v13
    v_lshlrev_b32 v62, 16, v14
    v_lshlrev_b32 v63, 16, v15
    v_mul_f32 v58, v46, v58
    v_mul_f32 v59, v46, v59
    v_mul_f32 v60, v46, v60
    v_mul_f32 v61, v46, v61
    v_mul_f32 v58, s50, v58
    v_mul_f32 v59, 0.15915494, v59
    v_pk_mul_f32 v[64:65], v[60:61], v[62:63] op_sel_hi:[1,0]
    v_pk_fma_f32 v[64:65], v[60:61], v[62:63], v[64:65] op_sel:[1,1,0] op_sel_hi:[0,1,1] neg_lo:[1,0,0]
    v_exp_f32 v48, v58
    v_fract_f32 v49, v59
    v_mul_f32 v54, 0x41000000, v58
    v_mul_f32 v55, 0x41000000, v59
    v_mul_f32 v56, 0x43800000, v58
    v_mul_f32 v57, 0x43800000, v59
    v_exp_f32 v54, v54
    v_fract_f32 v55, v55
    v_exp_f32 v56, v56
    v_fract_f32 v57, v57
    v_cos_f32 v58, v49
    v_sin_f32 v49, v49
    v_cos_f32 v59, v55
    v_sin_f32 v55, v55
    v_cos_f32 v60, v57
    v_sin_f32 v57, v57
    v_mul_f32 v49, v48, v49
    v_mul_f32 v48, v48, v58
    v_mul_f32 v55, v54, v55
    v_mul_f32 v54, v54, v59
    v_mul_f32 v57, v56, v57
    v_mul_f32 v56, v56, v60
    v_mov_b32 v114, v54
    v_mov_b32 v115, v55
    v_pk_mul_f32 v[50:51], v[48:49], v[48:49] op_sel_hi:[1,0]
    v_pk_mul_f32 v[116:117], v[54:55], v[54:55] op_sel_hi:[1,0]
    v_pk_mul_f32 v[66:67], v[64:65], v[48:49] op_sel_hi:[1,0]
    v_pk_mul_f32 v[80:81], v[64:65], v[56:57] op_sel_hi:[1,0]
    v_pk_fma_f32 v[50:51], v[48:49], v[48:49], v[50:51] op_sel:[1,1,0] op_sel_hi:[0,1,1] neg_lo:[1,0,0]
    v_pk_fma_f32 v[116:117], v[54:55], v[54:55], v[116:117] op_sel:[1,1,0] op_sel_hi:[0,1,1] neg_lo:[1,0,0]
    v_pk_fma_f32 v[66:67], v[64:65], v[48:49], v[66:67] op_sel:[1,1,0] op_sel_hi:[0,1,1] neg_lo:[1,0,0]
    v_pk_fma_f32 v[80:81], v[64:65], v[56:57], v[80:81] op_sel:[1,1,0] op_sel_hi:[0,1,1] neg_lo:[1,0,0]
    v_pk_mul_f32 v[52:53], v[50:51], v[50:51] op_sel_hi:[1,0]
    v_pk_mul_f32 v[118:119], v[116:117], v[54:55] op_sel_hi:[1,0]
    v_pk_mul_f32 v[120:121], v[116:117], v[116:117] op_sel_hi:[1,0]
    v_pk_mul_f32 v[68:69], v[64:65], v[50:51] op_sel_hi:[1,0]
    v_pk_mul_f32 v[70:71], v[66:67], v[50:51] op_sel_hi:[1,0]
    v_pk_mul_f32 v[82:83], v[80:81], v[50:51] op_sel_hi:[1,0]
    v_pk_mul_f32 v[84:85], v[80:81], v[56:57] op_sel_hi:[1,0]
    v_pk_fma_f32 v[52:53], v[50:51], v[50:51], v[52:53] op_sel:[1,1,0] op_sel_hi:[0,1,1] neg_lo:[1,0,0]
    v_pk_fma_f32 v[118:119], v[116:117], v[54:55], v[118:119] op_sel:[1,1,0] op_sel_hi:[0,1,1] neg_lo:[1,0,0]
    v_pk_fma_f32 v[120:121], v[116:117], v[116:117], v[120:121] op_sel:[1,1,0] op_sel_hi:[0,1,1] neg_lo:[1,0,0]
    v_pk_fma_f32 v[68:69], v[64:65], v[50:51], v[68:69] op_sel:[1,1,0] op_sel_hi:[0,1,1] neg_lo:[1,0,0]
    v_pk_fma_f32 v[70:71], v[66:67], v[50:51], v[70:71] op_sel:[1,1,0] op_sel_hi:[0,1,1] neg_lo:[1,0,0]
    v_pk_fma_f32 v[82:83], v[80:81], v[50:51], v[82:83] op_sel:[1,1,0] op_sel_hi:[0,1,1] neg_lo:[1,0,0]
    v_pk_fma_f32 v[84:85], v[80:81], v[56:57], v[84:85] op_sel:[1,1,0] op_sel_hi:[0,1,1] neg_lo:[1,0,0]
    v_pk_mul_f32 v[72:73], v[64:65], v[52:53] op_sel_hi:[1,0]
    v_pk_mul_f32 v[74:75], v[66:67], v[52:53] op_sel_hi:[1,0]
    v_pk_mul_f32 v[76:77], v[68:69], v[52:53] op_sel_hi:[1,0]
    v_pk_mul_f32 v[78:79], v[70:71], v[52:53] op_sel_hi:[1,0]
    v_pk_mul_f32 v[88:89], v[80:81], v[52:53] op_sel_hi:[1,0]
    v_pk_mul_f32 v[90:91], v[82:83], v[52:53] op_sel_hi:[1,0]
    v_pk_mul_f32 v[86:87], v[84:85], v[52:53] op_sel_hi:[1,0]
    v_pk_mul_f32 v[92:93], v[84:85], v[56:57] op_sel_hi:[1,0]
    v_pk_fma_f32 v[72:73], v[64:65], v[52:53], v[72:73] op_sel:[1,1,0] op_sel_hi:[0,1,1] neg_lo:[1,0,0]
    v_pk_fma_f32 v[74:75], v[66:67], v[52:53], v[74:75] op_sel:[1,1,0] op_sel_hi:[0,1,1] neg_lo:[1,0,0]
    v_pk_fma_f32 v[76:77], v[68:69], v[52:53], v[76:77] op_sel:[1,1,0] op_sel_hi:[0,1,1] neg_lo:[1,0,0]
    v_pk_fma_f32 v[78:79], v[70:71], v[52:53], v[78:79] op_sel:[1,1,0] op_sel_hi:[0,1,1] neg_lo:[1,0,0]
    v_pk_fma_f32 v[88:89], v[80:81], v[52:53], v[88:89] op_sel:[1,1,0] op_sel_hi:[0,1,1] neg_lo:[1,0,0]
    v_pk_fma_f32 v[90:91], v[82:83], v[52:53], v[90:91] op_sel:[1,1,0] op_sel_hi:[0,1,1] neg_lo:[1,0,0]
    v_pk_fma_f32 v[86:87], v[84:85], v[52:53], v[86:87] op_sel:[1,1,0] op_sel_hi:[0,1,1] neg_lo:[1,0,0]
    v_pk_fma_f32 v[92:93], v[84:85], v[56:57], v[92:93] op_sel:[1,1,0] op_sel_hi:[0,1,1] neg_lo:[1,0,0]
    v_pk_mul_f32 v[122:123], v[114:115], v[120:121] op_sel_hi:[1,0]
    v_pk_mul_f32 v[124:125], v[116:117], v[120:121] op_sel_hi:[1,0]
    v_pk_mul_f32 v[126:127], v[118:119], v[120:121] op_sel_hi:[1,0]
    v_pk_mul_f32 v[128:129], v[120:121], v[120:121] op_sel_hi:[1,0]
    v_pk_mul_f32 v[94:95], v[92:93], v[52:53] op_sel_hi:[1,0]
    v_pk_mul_f32 v[96:97], v[92:93], v[56:57] op_sel_hi:[1,0]
    v_pk_fma_f32 v[122:123], v[114:115], v[120:121], v[122:123] op_sel:[1,1,0] op_sel_hi:[0,1,1] neg_lo:[1,0,0]
    v_pk_fma_f32 v[124:125], v[116:117], v[120:121], v[124:125] op_sel:[1,1,0] op_sel_hi:[0,1,1] neg_lo:[1,0,0]
    v_pk_fma_f32 v[126:127], v[118:119], v[120:121], v[126:127] op_sel:[1,1,0] op_sel_hi:[0,1,1] neg_lo:[1,0,0]
    v_pk_fma_f32 v[128:129], v[120:121], v[120:121], v[128:129] op_sel:[1,1,0] op_sel_hi:[0,1,1] neg_lo:[1,0,0]
    v_pk_fma_f32 v[94:95], v[92:93], v[52:53], v[94:95] op_sel:[1,1,0] op_sel_hi:[0,1,1] neg_lo:[1,0,0]
    v_pk_fma_f32 v[96:97], v[92:93], v[56:57], v[96:97] op_sel:[1,1,0] op_sel_hi:[0,1,1] neg_lo:[1,0,0]
    v_pk_mul_f32 v[130:131], v[122:123], v[120:121] op_sel_hi:[1,0]
    v_pk_mul_f32 v[132:133], v[124:125], v[120:121] op_sel_hi:[1,0]
    v_pk_mul_f32 v[134:135], v[126:127], v[120:121] op_sel_hi:[1,0]
    v_pk_mul_f32 v[136:137], v[128:129], v[120:121] op_sel_hi:[1,0]
    v_pk_mul_f32 v[104:105], v[96:97], v[56:57] op_sel_hi:[1,0]
    v_pk_fma_f32 v[130:131], v[122:123], v[120:121], v[130:131] op_sel:[1,1,0] op_sel_hi:[0,1,1] neg_lo:[1,0,0]
    v_pk_fma_f32 v[132:133], v[124:125], v[120:121], v[132:133] op_sel:[1,1,0] op_sel_hi:[0,1,1] neg_lo:[1,0,0]
    v_pk_fma_f32 v[134:135], v[126:127], v[120:121], v[134:135] op_sel:[1,1,0] op_sel_hi:[0,1,1] neg_lo:[1,0,0]
    v_pk_fma_f32 v[136:137], v[128:129], v[120:121], v[136:137] op_sel:[1,1,0] op_sel_hi:[0,1,1] neg_lo:[1,0,0]
    v_pk_fma_f32 v[104:105], v[96:97], v[56:57], v[104:105] op_sel:[1,1,0] op_sel_hi:[0,1,1] neg_lo:[1,0,0]
    v_pk_mul_f32 v[138:139], v[130:131], v[120:121] op_sel_hi:[1,0]
    v_pk_mul_f32 v[140:141], v[132:133], v[120:121] op_sel_hi:[1,0]
    v_pk_mul_f32 v[142:143], v[134:135], v[120:121] op_sel_hi:[1,0]
    v_pk_mul_f32 v[144:145], v[136:137], v[120:121] op_sel_hi:[1,0]
    v_pk_mul_f32 v[98:99], v[104:105], v[56:57] op_sel_hi:[1,0]
    v_pk_fma_f32 v[138:139], v[130:131], v[120:121], v[138:139] op_sel:[1,1,0] op_sel_hi:[0,1,1] neg_lo:[1,0,0]
    v_pk_fma_f32 v[140:141], v[132:133], v[120:121], v[140:141] op_sel:[1,1,0] op_sel_hi:[0,1,1] neg_lo:[1,0,0]
    v_pk_fma_f32 v[142:143], v[134:135], v[120:121], v[142:143] op_sel:[1,1,0] op_sel_hi:[0,1,1] neg_lo:[1,0,0]
    v_pk_fma_f32 v[144:145], v[136:137], v[120:121], v[144:145] op_sel:[1,1,0] op_sel_hi:[0,1,1] neg_lo:[1,0,0]
    v_pk_fma_f32 v[98:99], v[104:105], v[56:57], v[98:99] op_sel:[1,1,0] op_sel_hi:[0,1,1] neg_lo:[1,0,0]
    v_pk_mul_f32 v[146:147], v[138:139], v[120:121] op_sel_hi:[1,0]
    v_pk_mul_f32 v[148:149], v[140:141], v[120:121] op_sel_hi:[1,0]
    v_pk_mul_f32 v[150:151], v[142:143], v[120:121] op_sel_hi:[1,0]
    v_pk_mul_f32 v[152:153], v[144:145], v[120:121] op_sel_hi:[1,0]
    v_pk_mul_f32 v[106:107], v[98:99], v[56:57] op_sel_hi:[1,0]
    v_pk_fma_f32 v[146:147], v[138:139], v[120:121], v[146:147] op_sel:[1,1,0] op_sel_hi:[0,1,1] neg_lo:[1,0,0]
    v_pk_fma_f32 v[148:149], v[140:141], v[120:121], v[148:149] op_sel:[1,1,0] op_sel_hi:[0,1,1] neg_lo:[1,0,0]
    v_pk_fma_f32 v[150:151], v[142:143], v[120:121], v[150:151] op_sel:[1,1,0] op_sel_hi:[0,1,1] neg_lo:[1,0,0]
    v_pk_fma_f32 v[152:153], v[144:145], v[120:121], v[152:153] op_sel:[1,1,0] op_sel_hi:[0,1,1] neg_lo:[1,0,0]
    v_pk_fma_f32 v[106:107], v[98:99], v[56:57], v[106:107] op_sel:[1,1,0] op_sel_hi:[0,1,1] neg_lo:[1,0,0]
    v_pk_mul_f32 v[154:155], v[146:147], v[120:121] op_sel_hi:[1,0]
    v_pk_mul_f32 v[156:157], v[148:149], v[120:121] op_sel_hi:[1,0]
    v_pk_mul_f32 v[158:159], v[150:151], v[120:121] op_sel_hi:[1,0]
    v_pk_mul_f32 v[160:161], v[152:153], v[120:121] op_sel_hi:[1,0]
    v_pk_mul_f32 v[100:101], v[106:107], v[56:57] op_sel_hi:[1,0]
    v_pk_fma_f32 v[154:155], v[146:147], v[120:121], v[154:155] op_sel:[1,1,0] op_sel_hi:[0,1,1] neg_lo:[1,0,0]
    v_pk_fma_f32 v[156:157], v[148:149], v[120:121], v[156:157] op_sel:[1,1,0] op_sel_hi:[0,1,1] neg_lo:[1,0,0]
    v_pk_fma_f32 v[158:159], v[150:151], v[120:121], v[158:159] op_sel:[1,1,0] op_sel_hi:[0,1,1] neg_lo:[1,0,0]
    v_pk_fma_f32 v[160:161], v[152:153], v[120:121], v[160:161] op_sel:[1,1,0] op_sel_hi:[0,1,1] neg_lo:[1,0,0]
    v_pk_fma_f32 v[100:101], v[106:107], v[56:57], v[100:101] op_sel:[1,1,0] op_sel_hi:[0,1,1] neg_lo:[1,0,0]
    v_pk_mul_f32 v[162:163], v[154:155], v[120:121] op_sel_hi:[1,0]
    v_pk_mul_f32 v[164:165], v[156:157], v[120:121] op_sel_hi:[1,0]
    v_pk_mul_f32 v[166:167], v[158:159], v[120:121] op_sel_hi:[1,0]
    v_pk_mul_f32 v[168:169], v[160:161], v[120:121] op_sel_hi:[1,0]
    v_pk_fma_f32 v[162:163], v[154:155], v[120:121], v[162:163] op_sel:[1,1,0] op_sel_hi:[0,1,1] neg_lo:[1,0,0]
    v_pk_fma_f32 v[164:165], v[156:157], v[120:121], v[164:165] op_sel:[1,1,0] op_sel_hi:[0,1,1] neg_lo:[1,0,0]
    v_pk_fma_f32 v[166:167], v[158:159], v[120:121], v[166:167] op_sel:[1,1,0] op_sel_hi:[0,1,1] neg_lo:[1,0,0]
    v_pk_fma_f32 v[168:169], v[160:161], v[120:121], v[168:169] op_sel:[1,1,0] op_sel_hi:[0,1,1] neg_lo:[1,0,0]
    v_cvt_pk_bf16_f32 v176, v64, v66
    v_cvt_pk_bf16_f32 v188, -v65, -v67
    v_cvt_pk_bf16_f32 v177, v68, v70
    v_cvt_pk_bf16_f32 v189, -v69, -v71
    v_cvt_pk_bf16_f32 v178, v72, v74
    v_cvt_pk_bf16_f32 v190, -v73, -v75
    v_cvt_pk_bf16_f32 v179, v76, v78
    v_cvt_pk_bf16_f32 v191, -v77, -v79
    v_cvt_pk_bf16_f32 v180, v80, v82
    v_cvt_pk_bf16_f32 v192, -v81, -v83
    v_cvt_pk_bf16_f32 v181, v84, v86
    v_cvt_pk_bf16_f32 v193, -v85, -v87
    v_cvt_pk_bf16_f32 v182, v88, v90
    v_cvt_pk_bf16_f32 v194, -v89, -v91
    v_cvt_pk_bf16_f32 v183, v92, v94
    v_cvt_pk_bf16_f32 v195, -v93, -v95
    v_cvt_pk_bf16_f32 v184, v96, v98
    v_cvt_pk_bf16_f32 v196, -v97, -v99
    v_cvt_pk_bf16_f32 v185, v100, v100
    v_cvt_pk_bf16_f32 v197, -v101, -v101
    v_cvt_pk_bf16_f32 v186, v104, v106
    v_cvt_pk_bf16_f32 v198, -v105, -v107
    v_pk_mul_f32 v[170:171], v[162:163], v[120:121] op_sel_hi:[1,0]
    v_pk_mul_f32 v[172:173], v[164:165], v[120:121] op_sel_hi:[1,0]
    v_pk_mul_f32 v[174:175], v[166:167], v[120:121] op_sel_hi:[1,0]
    v_pk_fma_f32 v[170:171], v[162:163], v[120:121], v[170:171] op_sel:[1,1,0] op_sel_hi:[0,1,1] neg_lo:[1,0,0]
    v_pk_fma_f32 v[172:173], v[164:165], v[120:121], v[172:173] op_sel:[1,1,0] op_sel_hi:[0,1,1] neg_lo:[1,0,0]
    v_pk_fma_f32 v[174:175], v[166:167], v[120:121], v[174:175] op_sel:[1,1,0] op_sel_hi:[0,1,1] neg_lo:[1,0,0]
    v_cvt_pk_bf16_f32 v64, 1.0, v114
    v_cvt_pk_bf16_f32 v80, 0, v115
    v_cvt_pk_bf16_f32 v65, v116, v118
    v_cvt_pk_bf16_f32 v81, v117, v119
    v_cvt_pk_bf16_f32 v66, v120, v122
    v_cvt_pk_bf16_f32 v82, v121, v123
    v_cvt_pk_bf16_f32 v67, v124, v126
    v_cvt_pk_bf16_f32 v83, v125, v127
    v_cvt_pk_bf16_f32 v68, v128, v130
    v_cvt_pk_bf16_f32 v84, v129, v131
    v_cvt_pk_bf16_f32 v69, v132, v134
    v_cvt_pk_bf16_f32 v85, v133, v135
    v_cvt_pk_bf16_f32 v70, v136, v138
    v_cvt_pk_bf16_f32 v86, v137, v139
    v_cvt_pk_bf16_f32 v71, v140, v142
    v_cvt_pk_bf16_f32 v87, v141, v143
    v_cvt_pk_bf16_f32 v72, v144, v146
    v_cvt_pk_bf16_f32 v88, v145, v147
    v_cvt_pk_bf16_f32 v73, v148, v150
    v_cvt_pk_bf16_f32 v89, v149, v151
    v_cvt_pk_bf16_f32 v74, v152, v154
    v_cvt_pk_bf16_f32 v90, v153, v155
    v_cvt_pk_bf16_f32 v75, v156, v158
    v_cvt_pk_bf16_f32 v91, v157, v159
    v_cvt_pk_bf16_f32 v76, v160, v162
    v_cvt_pk_bf16_f32 v92, v161, v163
    v_cvt_pk_bf16_f32 v77, v164, v166
    v_cvt_pk_bf16_f32 v93, v165, v167
    v_cvt_pk_bf16_f32 v78, v168, v170
    v_cvt_pk_bf16_f32 v94, v169, v171
    v_cvt_pk_bf16_f32 v79, v172, v174
    v_cvt_pk_bf16_f32 v95, v173, v175
    ds_write_b128 v16, v[176:179] offset:8192
    ds_write_b128 v16, v[188:191] offset:12288
    ds_write_b128 v17, v[180:183] offset:8192
    ds_write_b128 v17, v[192:195] offset:12288
    ds_write_b128 v18, v[184:187] offset:8192
    ds_write_b128 v18, v[196:199] offset:12288
    ds_write_b128 v16, v[64:67]
    ds_write_b128 v16, v[80:83] offset:4096
    ds_write_b128 v17, v[68:71]
    ds_write_b128 v17, v[84:87] offset:4096
    ds_write_b128 v18, v[72:75]
    ds_write_b128 v18, v[88:91] offset:4096
    ds_write_b128 v19, v[76:79]
    ds_write_b128 v19, v[92:95] offset:4096
    v_and_b32 v58, 0xffff0000, v10
    v_and_b32 v59, 0xffff0000, v11
    v_and_b32 v60, 0xffff0000, v12
    v_and_b32 v61, 0xffff0000, v13
    v_and_b32 v62, 0xffff0000, v14
    v_and_b32 v63, 0xffff0000, v15
    v_mul_f32 v58, v46, v58
    v_mul_f32 v59, v46, v59
    v_mul_f32 v60, v46, v60
    v_mul_f32 v61, v46, v61
    v_mul_f32 v58, s50, v58
    v_mul_f32 v59, 0.15915494, v59
    v_pk_mul_f32 v[64:65], v[60:61], v[62:63] op_sel_hi:[1,0]
    v_pk_fma_f32 v[64:65], v[60:61], v[62:63], v[64:65] op_sel:[1,1,0] op_sel_hi:[0,1,1] neg_lo:[1,0,0]
    v_exp_f32 v48, v58
    v_fract_f32 v49, v59
    v_mul_f32 v54, 0x41000000, v58
    v_mul_f32 v55, 0x41000000, v59
    v_mul_f32 v56, 0x43800000, v58
    ds_read_b64_tr_b16 v[200:201], v20 offset:8192
    ds_read_b64_tr_b16 v[202:203], v21 offset:8192
    ds_read_b64_tr_b16 v[204:205], v20 offset:0
    ds_read_b64_tr_b16 v[206:207], v21 offset:0
    ds_read_b64_tr_b16 v[208:209], v20 offset:9216
    ds_read_b64_tr_b16 v[210:211], v21 offset:9216
    ds_read_b64_tr_b16 v[212:213], v20 offset:1024
    ds_read_b64_tr_b16 v[214:215], v21 offset:1024
    ds_read_b64_tr_b16 v[216:217], v20 offset:10240
    ds_read_b64_tr_b16 v[218:219], v21 offset:10240
    ds_read_b64_tr_b16 v[220:221], v20 offset:2048
    ds_read_b64_tr_b16 v[222:223], v21 offset:2048
    v_mul_f32 v57, 0x43800000, v59
    v_exp_f32 v54, v54
    v_fract_f32 v55, v55
    v_exp_f32 v56, v56
    v_fract_f32 v57, v57
    v_cos_f32 v58, v49
    v_sin_f32 v49, v49
    v_cos_f32 v59, v55
    v_sin_f32 v55, v55
    v_cos_f32 v60, v57
    v_sin_f32 v57, v57
    v_mul_f32 v49, v48, v49
    v_mul_f32 v48, v48, v58
    v_mul_f32 v55, v54, v55
    v_mul_f32 v54, v54, v59
    v_mul_f32 v57, v56, v57
    v_mul_f32 v56, v56, v60
    v_mov_b32 v114, v54
    v_mov_b32 v115, v55
    s_waitcnt lgkmcnt(8)
    v_mfma_f32_32x32x16_bf16 v[232:247], v[200:203], v[204:207], 0
    ds_read_b64_tr_b16 v[224:225], v20 offset:11264
    ds_read_b64_tr_b16 v[226:227], v21 offset:11264
    ds_read_b64_tr_b16 v[228:229], v20 offset:3072
    ds_read_b64_tr_b16 v[230:231], v21 offset:3072
    v_pk_mul_f32 v[50:51], v[48:49], v[48:49] op_sel_hi:[1,0]
    v_pk_mul_f32 v[116:117], v[54:55], v[54:55] op_sel_hi:[1,0]
    v_pk_mul_f32 v[66:67], v[64:65], v[48:49] op_sel_hi:[1,0]
    v_pk_mul_f32 v[80:81], v[64:65], v[56:57] op_sel_hi:[1,0]
    v_pk_fma_f32 v[50:51], v[48:49], v[48:49], v[50:51] op_sel:[1,1,0] op_sel_hi:[0,1,1] neg_lo:[1,0,0]
    v_pk_fma_f32 v[116:117], v[54:55], v[54:55], v[116:117] op_sel:[1,1,0] op_sel_hi:[0,1,1] neg_lo:[1,0,0]
    v_pk_fma_f32 v[66:67], v[64:65], v[48:49], v[66:67] op_sel:[1,1,0] op_sel_hi:[0,1,1] neg_lo:[1,0,0]
    v_pk_fma_f32 v[80:81], v[64:65], v[56:57], v[80:81] op_sel:[1,1,0] op_sel_hi:[0,1,1] neg_lo:[1,0,0]
    v_pk_mul_f32 v[52:53], v[50:51], v[50:51] op_sel_hi:[1,0]
    v_pk_mul_f32 v[118:119], v[116:117], v[54:55] op_sel_hi:[1,0]
    v_pk_mul_f32 v[120:121], v[116:117], v[116:117] op_sel_hi:[1,0]
    v_pk_mul_f32 v[68:69], v[64:65], v[50:51] op_sel_hi:[1,0]
    v_pk_mul_f32 v[70:71], v[66:67], v[50:51] op_sel_hi:[1,0]
    v_pk_mul_f32 v[82:83], v[80:81], v[50:51] op_sel_hi:[1,0]
    v_pk_mul_f32 v[84:85], v[80:81], v[56:57] op_sel_hi:[1,0]
    v_pk_fma_f32 v[52:53], v[50:51], v[50:51], v[52:53] op_sel:[1,1,0] op_sel_hi:[0,1,1] neg_lo:[1,0,0]
    v_pk_fma_f32 v[118:119], v[116:117], v[54:55], v[118:119] op_sel:[1,1,0] op_sel_hi:[0,1,1] neg_lo:[1,0,0]
    v_pk_fma_f32 v[120:121], v[116:117], v[116:117], v[120:121] op_sel:[1,1,0] op_sel_hi:[0,1,1] neg_lo:[1,0,0]
    v_pk_fma_f32 v[68:69], v[64:65], v[50:51], v[68:69] op_sel:[1,1,0] op_sel_hi:[0,1,1] neg_lo:[1,0,0]
    s_waitcnt lgkmcnt(8)
    v_mfma_f32_32x32x16_bf16 v[232:247], v[208:211], v[212:215], v[232:247]
    ds_read_b64_tr_b16 v[200:201], v20 offset:12288
    ds_read_b64_tr_b16 v[202:203], v21 offset:12288
    ds_read_b64_tr_b16 v[204:205], v20 offset:4096
    ds_read_b64_tr_b16 v[206:207], v21 offset:4096
    v_pk_fma_f32 v[70:71], v[66:67], v[50:51], v[70:71] op_sel:[1,1,0] op_sel_hi:[0,1,1] neg_lo:[1,0,0]
    v_pk_fma_f32 v[82:83], v[80:81], v[50:51], v[82:83] op_sel:[1,1,0] op_sel_hi:[0,1,1] neg_lo:[1,0,0]
    v_pk_fma_f32 v[84:85], v[80:81], v[56:57], v[84:85] op_sel:[1,1,0] op_sel_hi:[0,1,1] neg_lo:[1,0,0]
    v_pk_mul_f32 v[72:73], v[64:65], v[52:53] op_sel_hi:[1,0]
    v_pk_mul_f32 v[74:75], v[66:67], v[52:53] op_sel_hi:[1,0]
    v_pk_mul_f32 v[76:77], v[68:69], v[52:53] op_sel_hi:[1,0]
    v_pk_mul_f32 v[78:79], v[70:71], v[52:53] op_sel_hi:[1,0]
    v_pk_mul_f32 v[88:89], v[80:81], v[52:53] op_sel_hi:[1,0]
    v_pk_mul_f32 v[90:91], v[82:83], v[52:53] op_sel_hi:[1,0]
    v_pk_mul_f32 v[86:87], v[84:85], v[52:53] op_sel_hi:[1,0]
    v_pk_mul_f32 v[92:93], v[84:85], v[56:57] op_sel_hi:[1,0]
    v_pk_fma_f32 v[72:73], v[64:65], v[52:53], v[72:73] op_sel:[1,1,0] op_sel_hi:[0,1,1] neg_lo:[1,0,0]
    v_pk_fma_f32 v[74:75], v[66:67], v[52:53], v[74:75] op_sel:[1,1,0] op_sel_hi:[0,1,1] neg_lo:[1,0,0]
    v_pk_fma_f32 v[76:77], v[68:69], v[52:53], v[76:77] op_sel:[1,1,0] op_sel_hi:[0,1,1] neg_lo:[1,0,0]
    v_pk_fma_f32 v[78:79], v[70:71], v[52:53], v[78:79] op_sel:[1,1,0] op_sel_hi:[0,1,1] neg_lo:[1,0,0]
    v_pk_fma_f32 v[88:89], v[80:81], v[52:53], v[88:89] op_sel:[1,1,0] op_sel_hi:[0,1,1] neg_lo:[1,0,0]
    v_pk_fma_f32 v[90:91], v[82:83], v[52:53], v[90:91] op_sel:[1,1,0] op_sel_hi:[0,1,1] neg_lo:[1,0,0]
    v_pk_fma_f32 v[86:87], v[84:85], v[52:53], v[86:87] op_sel:[1,1,0] op_sel_hi:[0,1,1] neg_lo:[1,0,0]
    v_pk_fma_f32 v[92:93], v[84:85], v[56:57], v[92:93] op_sel:[1,1,0] op_sel_hi:[0,1,1] neg_lo:[1,0,0]
    s_waitcnt lgkmcnt(8)
    v_mfma_f32_32x32x16_bf16 v[232:247], v[216:219], v[220:223], v[232:247]
    ds_read_b64_tr_b16 v[208:209], v20 offset:13312
    ds_read_b64_tr_b16 v[210:211], v21 offset:13312
    ds_read_b64_tr_b16 v[212:213], v20 offset:5120
    ds_read_b64_tr_b16 v[214:215], v21 offset:5120
    v_pk_mul_f32 v[122:123], v[114:115], v[120:121] op_sel_hi:[1,0]
    v_pk_mul_f32 v[124:125], v[116:117], v[120:121] op_sel_hi:[1,0]
    v_pk_mul_f32 v[126:127], v[118:119], v[120:121] op_sel_hi:[1,0]
    v_pk_mul_f32 v[128:129], v[120:121], v[120:121] op_sel_hi:[1,0]
    v_pk_mul_f32 v[94:95], v[92:93], v[52:53] op_sel_hi:[1,0]
    v_pk_mul_f32 v[96:97], v[92:93], v[56:57] op_sel_hi:[1,0]
    v_pk_fma_f32 v[122:123], v[114:115], v[120:121], v[122:123] op_sel:[1,1,0] op_sel_hi:[0,1,1] neg_lo:[1,0,0]
    v_pk_fma_f32 v[124:125], v[116:117], v[120:121], v[124:125] op_sel:[1,1,0] op_sel_hi:[0,1,1] neg_lo:[1,0,0]
    v_pk_fma_f32 v[126:127], v[118:119], v[120:121], v[126:127] op_sel:[1,1,0] op_sel_hi:[0,1,1] neg_lo:[1,0,0]
    v_pk_fma_f32 v[128:129], v[120:121], v[120:121], v[128:129] op_sel:[1,1,0] op_sel_hi:[0,1,1] neg_lo:[1,0,0]
    v_pk_fma_f32 v[94:95], v[92:93], v[52:53], v[94:95] op_sel:[1,1,0] op_sel_hi:[0,1,1] neg_lo:[1,0,0]
    v_pk_fma_f32 v[96:97], v[92:93], v[56:57], v[96:97] op_sel:[1,1,0] op_sel_hi:[0,1,1] neg_lo:[1,0,0]
    v_pk_mul_f32 v[130:131], v[122:123], v[120:121] op_sel_hi:[1,0]
    v_pk_mul_f32 v[132:133], v[124:125], v[120:121] op_sel_hi:[1,0]
    v_pk_mul_f32 v[134:135], v[126:127], v[120:121] op_sel_hi:[1,0]
    v_pk_mul_f32 v[136:137], v[128:129], v[120:121] op_sel_hi:[1,0]
    v_pk_mul_f32 v[104:105], v[96:97], v[56:57] op_sel_hi:[1,0]
    v_pk_fma_f32 v[130:131], v[122:123], v[120:121], v[130:131] op_sel:[1,1,0] op_sel_hi:[0,1,1] neg_lo:[1,0,0]
    v_pk_fma_f32 v[132:133], v[124:125], v[120:121], v[132:133] op_sel:[1,1,0] op_sel_hi:[0,1,1] neg_lo:[1,0,0]
    s_waitcnt lgkmcnt(8)
    v_mfma_f32_32x32x16_bf16 v[232:247], v[224:227], v[228:231], v[232:247]
    ds_read_b64_tr_b16 v[216:217], v20 offset:14336
    ds_read_b64_tr_b16 v[218:219], v21 offset:14336
    ds_read_b64_tr_b16 v[220:221], v20 offset:6144
    ds_read_b64_tr_b16 v[222:223], v21 offset:6144
    v_pk_fma_f32 v[134:135], v[126:127], v[120:121], v[134:135] op_sel:[1,1,0] op_sel_hi:[0,1,1] neg_lo:[1,0,0]
    v_pk_fma_f32 v[136:137], v[128:129], v[120:121], v[136:137] op_sel:[1,1,0] op_sel_hi:[0,1,1] neg_lo:[1,0,0]
    v_pk_fma_f32 v[104:105], v[96:97], v[56:57], v[104:105] op_sel:[1,1,0] op_sel_hi:[0,1,1] neg_lo:[1,0,0]
    v_pk_mul_f32 v[138:139], v[130:131], v[120:121] op_sel_hi:[1,0]
    v_pk_mul_f32 v[140:141], v[132:133], v[120:121] op_sel_hi:[1,0]
    v_pk_mul_f32 v[142:143], v[134:135], v[120:121] op_sel_hi:[1,0]
    v_pk_mul_f32 v[144:145], v[136:137], v[120:121] op_sel_hi:[1,0]
    v_pk_mul_f32 v[98:99], v[104:105], v[56:57] op_sel_hi:[1,0]
    v_pk_fma_f32 v[138:139], v[130:131], v[120:121], v[138:139] op_sel:[1,1,0] op_sel_hi:[0,1,1] neg_lo:[1,0,0]
    v_pk_fma_f32 v[140:141], v[132:133], v[120:121], v[140:141] op_sel:[1,1,0] op_sel_hi:[0,1,1] neg_lo:[1,0,0]
    v_pk_fma_f32 v[142:143], v[134:135], v[120:121], v[142:143] op_sel:[1,1,0] op_sel_hi:[0,1,1] neg_lo:[1,0,0]
    v_pk_fma_f32 v[144:145], v[136:137], v[120:121], v[144:145] op_sel:[1,1,0] op_sel_hi:[0,1,1] neg_lo:[1,0,0]
    v_pk_fma_f32 v[98:99], v[104:105], v[56:57], v[98:99] op_sel:[1,1,0] op_sel_hi:[0,1,1] neg_lo:[1,0,0]
    v_pk_mul_f32 v[146:147], v[138:139], v[120:121] op_sel_hi:[1,0]
    v_pk_mul_f32 v[148:149], v[140:141], v[120:121] op_sel_hi:[1,0]
    v_pk_mul_f32 v[150:151], v[142:143], v[120:121] op_sel_hi:[1,0]
    v_pk_mul_f32 v[152:153], v[144:145], v[120:121] op_sel_hi:[1,0]
    v_pk_mul_f32 v[106:107], v[98:99], v[56:57] op_sel_hi:[1,0]
    v_pk_fma_f32 v[146:147], v[138:139], v[120:121], v[146:147] op_sel:[1,1,0] op_sel_hi:[0,1,1] neg_lo:[1,0,0]
    s_waitcnt lgkmcnt(8)
    v_mfma_f32_32x32x16_bf16 v[232:247], v[200:203], v[204:207], v[232:247]
    ds_read_b64_tr_b16 v[224:225], v20 offset:15360
    ds_read_b64_tr_b16 v[226:227], v21 offset:15360
    ds_read_b64_tr_b16 v[228:229], v20 offset:7168
    ds_read_b64_tr_b16 v[230:231], v21 offset:7168
    v_pk_fma_f32 v[148:149], v[140:141], v[120:121], v[148:149] op_sel:[1,1,0] op_sel_hi:[0,1,1] neg_lo:[1,0,0]
    v_pk_fma_f32 v[150:151], v[142:143], v[120:121], v[150:151] op_sel:[1,1,0] op_sel_hi:[0,1,1] neg_lo:[1,0,0]
    v_pk_fma_f32 v[152:153], v[144:145], v[120:121], v[152:153] op_sel:[1,1,0] op_sel_hi:[0,1,1] neg_lo:[1,0,0]
    v_pk_fma_f32 v[106:107], v[98:99], v[56:57], v[106:107] op_sel:[1,1,0] op_sel_hi:[0,1,1] neg_lo:[1,0,0]
    v_pk_mul_f32 v[154:155], v[146:147], v[120:121] op_sel_hi:[1,0]
    v_pk_mul_f32 v[156:157], v[148:149], v[120:121] op_sel_hi:[1,0]
    v_pk_mul_f32 v[158:159], v[150:151], v[120:121] op_sel_hi:[1,0]
    v_pk_mul_f32 v[160:161], v[152:153], v[120:121] op_sel_hi:[1,0]
    v_pk_mul_f32 v[100:101], v[106:107], v[56:57] op_sel_hi:[1,0]
    v_pk_fma_f32 v[154:155], v[146:147], v[120:121], v[154:155] op_sel:[1,1,0] op_sel_hi:[0,1,1] neg_lo:[1,0,0]
    v_pk_fma_f32 v[156:157], v[148:149], v[120:121], v[156:157] op_sel:[1,1,0] op_sel_hi:[0,1,1] neg_lo:[1,0,0]
    v_pk_fma_f32 v[158:159], v[150:151], v[120:121], v[158:159] op_sel:[1,1,0] op_sel_hi:[0,1,1] neg_lo:[1,0,0]
    v_pk_fma_f32 v[160:161], v[152:153], v[120:121], v[160:161] op_sel:[1,1,0] op_sel_hi:[0,1,1] neg_lo:[1,0,0]
    v_pk_fma_f32 v[100:101], v[106:107], v[56:57], v[100:101] op_sel:[1,1,0] op_sel_hi:[0,1,1] neg_lo:[1,0,0]
    v_pk_mul_f32 v[162:163], v[154:155], v[120:121] op_sel_hi:[1,0]
    v_pk_mul_f32 v[164:165], v[156:157], v[120:121] op_sel_hi:[1,0]
    v_pk_mul_f32 v[166:167], v[158:159], v[120:121] op_sel_hi:[1,0]
    v_pk_mul_f32 v[168:169], v[160:161], v[120:121] op_sel_hi:[1,0]
    v_pk_fma_f32 v[162:163], v[154:155], v[120:121], v[162:163] op_sel:[1,1,0] op_sel_hi:[0,1,1] neg_lo:[1,0,0]
    s_waitcnt lgkmcnt(8)
    v_mfma_f32_32x32x16_bf16 v[232:247], v[208:211], v[212:215], v[232:247]
    v_pk_fma_f32 v[164:165], v[156:157], v[120:121], v[164:165] op_sel:[1,1,0] op_sel_hi:[0,1,1] neg_lo:[1,0,0]
    v_pk_fma_f32 v[166:167], v[158:159], v[120:121], v[166:167] op_sel:[1,1,0] op_sel_hi:[0,1,1] neg_lo:[1,0,0]
    v_pk_fma_f32 v[168:169], v[160:161], v[120:121], v[168:169] op_sel:[1,1,0] op_sel_hi:[0,1,1] neg_lo:[1,0,0]
    v_cvt_pk_bf16_f32 v176, v64, v66
    v_cvt_pk_bf16_f32 v188, -v65, -v67
    v_cvt_pk_bf16_f32 v177, v68, v70
    v_cvt_pk_bf16_f32 v189, -v69, -v71
    v_cvt_pk_bf16_f32 v178, v72, v74
    v_cvt_pk_bf16_f32 v190, -v73, -v75
    v_cvt_pk_bf16_f32 v179, v76, v78
    v_cvt_pk_bf16_f32 v191, -v77, -v79
    v_cvt_pk_bf16_f32 v180, v80, v82
    v_cvt_pk_bf16_f32 v192, -v81, -v83
    v_cvt_pk_bf16_f32 v181, v84, v86
    v_cvt_pk_bf16_f32 v193, -v85, -v87
    v_cvt_pk_bf16_f32 v182, v88, v90
    v_cvt_pk_bf16_f32 v194, -v89, -v91
    v_cvt_pk_bf16_f32 v183, v92, v94
    v_cvt_pk_bf16_f32 v195, -v93, -v95
    s_waitcnt lgkmcnt(4)
    v_mfma_f32_32x32x16_bf16 v[232:247], v[216:219], v[220:223], v[232:247]
    v_cvt_pk_bf16_f32 v184, v96, v98
    v_cvt_pk_bf16_f32 v196, -v97, -v99
    v_cvt_pk_bf16_f32 v185, v100, v100
    v_cvt_pk_bf16_f32 v197, -v101, -v101
    v_cvt_pk_bf16_f32 v186, v104, v106
    v_cvt_pk_bf16_f32 v198, -v105, -v107
    v_pk_mul_f32 v[170:171], v[162:163], v[120:121] op_sel_hi:[1,0]
    v_pk_mul_f32 v[172:173], v[164:165], v[120:121] op_sel_hi:[1,0]
    v_pk_mul_f32 v[174:175], v[166:167], v[120:121] op_sel_hi:[1,0]
    v_pk_fma_f32 v[170:171], v[162:163], v[120:121], v[170:171] op_sel:[1,1,0] op_sel_hi:[0,1,1] neg_lo:[1,0,0]
    v_pk_fma_f32 v[172:173], v[164:165], v[120:121], v[172:173] op_sel:[1,1,0] op_sel_hi:[0,1,1] neg_lo:[1,0,0]
    v_pk_fma_f32 v[174:175], v[166:167], v[120:121], v[174:175] op_sel:[1,1,0] op_sel_hi:[0,1,1] neg_lo:[1,0,0]
    v_cvt_pk_bf16_f32 v64, 1.0, v114
    v_cvt_pk_bf16_f32 v80, 0, v115
    v_cvt_pk_bf16_f32 v65, v116, v118
    v_cvt_pk_bf16_f32 v81, v117, v119
    v_cvt_pk_bf16_f32 v66, v120, v122
    v_cvt_pk_bf16_f32 v82, v121, v123
    v_cvt_pk_bf16_f32 v67, v124, v126
    s_waitcnt lgkmcnt(0)
    v_mfma_f32_32x32x16_bf16 v[232:247], v[224:227], v[228:231], v[232:247]
    v_cvt_pk_bf16_f32 v83, v125, v127
    v_cvt_pk_bf16_f32 v68, v128, v130
    v_cvt_pk_bf16_f32 v84, v129, v131
    v_cvt_pk_bf16_f32 v69, v132, v134
    v_cvt_pk_bf16_f32 v85, v133, v135
    v_cvt_pk_bf16_f32 v70, v136, v138
    v_cvt_pk_bf16_f32 v86, v137, v139
    v_cvt_pk_bf16_f32 v71, v140, v142
    v_cvt_pk_bf16_f32 v87, v141, v143
    v_cvt_pk_bf16_f32 v72, v144, v146
    v_cvt_pk_bf16_f32 v88, v145, v147
    v_cvt_pk_bf16_f32 v73, v148, v150
    v_cvt_pk_bf16_f32 v89, v149, v151
    v_cvt_pk_bf16_f32 v74, v152, v154
    v_cvt_pk_bf16_f32 v90, v153, v155
    v_cvt_pk_bf16_f32 v75, v156, v158
    v_cvt_pk_bf16_f32 v91, v157, v159
    v_cvt_pk_bf16_f32 v76, v160, v162
    v_cvt_pk_bf16_f32 v92, v161, v163
    v_cvt_pk_bf16_f32 v77, v164, v166
    v_cvt_pk_bf16_f32 v93, v165, v167
    v_cvt_pk_bf16_f32 v78, v168, v170
    v_cvt_pk_bf16_f32 v94, v169, v171
    v_cvt_pk_bf16_f32 v79, v172, v174
    v_cvt_pk_bf16_f32 v95, v173, v175
    ds_write_b128 v16, v[176:179] offset:8192
    ds_write_b128 v16, v[188:191] offset:12288
    ds_write_b128 v17, v[180:183] offset:8192
    ds_write_b128 v17, v[192:195] offset:12288
    ds_write_b128 v18, v[184:187] offset:8192
    ds_write_b128 v18, v[196:199] offset:12288
    ds_write_b128 v16, v[64:67]
    ds_write_b128 v16, v[80:83] offset:4096
    ds_write_b128 v17, v[68:71]
    ds_write_b128 v17, v[84:87] offset:4096
    ds_write_b128 v18, v[72:75]
    ds_write_b128 v18, v[88:91] offset:4096
    ds_write_b128 v19, v[76:79]
    ds_write_b128 v19, v[92:95] offset:4096
    ds_read_b64_tr_b16 v[200:201], v20 offset:8192
    ds_read_b64_tr_b16 v[202:203], v21 offset:8192
    ds_read_b64_tr_b16 v[204:205], v20 offset:0
    ds_read_b64_tr_b16 v[206:207], v21 offset:0
    ds_read_b64_tr_b16 v[208:209], v20 offset:9216
    ds_read_b64_tr_b16 v[210:211], v21 offset:9216
    ds_read_b64_tr_b16 v[212:213], v20 offset:1024
    ds_read_b64_tr_b16 v[214:215], v21 offset:1024
    ds_read_b64_tr_b16 v[216:217], v20 offset:10240
    ds_read_b64_tr_b16 v[218:219], v21 offset:10240
    ds_read_b64_tr_b16 v[220:221], v20 offset:2048
    ds_read_b64_tr_b16 v[222:223], v21 offset:2048
    s_waitcnt lgkmcnt(8)
    v_mfma_f32_32x32x16_bf16 v[232:247], v[200:203], v[204:207], v[232:247]
    ds_read_b64_tr_b16 v[224:225], v20 offset:11264
    ds_read_b64_tr_b16 v[226:227], v21 offset:11264
    ds_read_b64_tr_b16 v[228:229], v20 offset:3072
    ds_read_b64_tr_b16 v[230:231], v21 offset:3072
    s_waitcnt lgkmcnt(8)
    v_mfma_f32_32x32x16_bf16 v[232:247], v[208:211], v[212:215], v[232:247]
    ds_read_b64_tr_b16 v[200:201], v20 offset:12288
    ds_read_b64_tr_b16 v[202:203], v21 offset:12288
    ds_read_b64_tr_b16 v[204:205], v20 offset:4096
    ds_read_b64_tr_b16 v[206:207], v21 offset:4096
    s_waitcnt lgkmcnt(8)
    v_mfma_f32_32x32x16_bf16 v[232:247], v[216:219], v[220:223], v[232:247]
    ds_read_b64_tr_b16 v[208:209], v20 offset:13312
    ds_read_b64_tr_b16 v[210:211], v21 offset:13312
    ds_read_b64_tr_b16 v[212:213], v20 offset:5120
    ds_read_b64_tr_b16 v[214:215], v21 offset:5120
    s_waitcnt lgkmcnt(8)
    v_mfma_f32_32x32x16_bf16 v[232:247], v[224:227], v[228:231], v[232:247]
    ds_read_b64_tr_b16 v[216:217], v20 offset:14336
    ds_read_b64_tr_b16 v[218:219], v21 offset:14336
    ds_read_b64_tr_b16 v[220:221], v20 offset:6144
    ds_read_b64_tr_b16 v[222:223], v21 offset:6144
    s_waitcnt lgkmcnt(8)
    v_mfma_f32_32x32x16_bf16 v[232:247], v[200:203], v[204:207], v[232:247]
    ds_read_b64_tr_b16 v[224:225], v20 offset:15360
    ds_read_b64_tr_b16 v[226:227], v21 offset:15360
    ds_read_b64_tr_b16 v[228:229], v20 offset:7168
    ds_read_b64_tr_b16 v[230:231], v21 offset:7168
    s_waitcnt lgkmcnt(8)
    v_mfma_f32_32x32x16_bf16 v[232:247], v[208:211], v[212:215], v[232:247]
    s_waitcnt lgkmcnt(4)
    v_mfma_f32_32x32x16_bf16 v[232:247], v[216:219], v[220:223], v[232:247]
    s_waitcnt lgkmcnt(0)
    v_mfma_f32_32x32x16_bf16 v[232:247], v[224:227], v[228:231], v[232:247]
    v_lshlrev_b32 v4, 3, v1
    v_add_u32 v3, s48, v4
    s_xor_b32 s30, s48, 16384
    v_add_u32 v4, s30, v4
    s_nop 7
    s_cmp_eq_u32 s29, 1
    s_cbranch_scc1 hh_k4_kernel_b1h1
    ds_write_b64 v3, v[238:239] offset:1024
    ds_write_b128 v42, v[240:243]
    s_waitcnt vmcnt(0) lgkmcnt(0)
    s_barrier
    ds_read_b128 v[64:67], v43
    ds_read_b64 v[68:69], v4 offset:1024
    ds_read_b64_tr_b16 v[72:73], v40 offset:0
    ds_read_b64_tr_b16 v[74:75], v40 offset:512
    ds_read_b64_tr_b16 v[76:77], v40 offset:4096
    ds_read_b64_tr_b16 v[78:79], v40 offset:4608
    s_waitcnt lgkmcnt(4)
    v_add_f32 v64, v64, v232
    v_add_f32 v65, v65, v233
    v_add_f32 v66, v66, v234
    v_add_f32 v67, v67, v235
    v_add_f32 v68, v68, v236
    v_add_f32 v69, v69, v237
    v_add_f32 v64, v64, v47
    v_cvt_pk_bf16_f32 v64, v64, v65
    v_cvt_pk_bf16_f32 v65, v66, v67
    v_cvt_pk_bf16_f32 v66, v68, v69
    ds_write_b64 v44, v[64:65]
    ds_write_b16 v44, v66 offset:512
    ds_write_b16_d16_hi v44, v66 offset:516
    s_branch hh_k4_kernel_b1h1_join
hh_k4_kernel_b1h1:
    ds_write_b128 v42, v[232:235]
    ds_write_b64 v3, v[236:237] offset:1024
    s_waitcnt vmcnt(0) lgkmcnt(0)
    s_barrier
    ds_read_b128 v[64:67], v43
    ds_read_b64 v[68:69], v4 offset:1024
    ds_read_b64_tr_b16 v[72:73], v40 offset:0
    ds_read_b64_tr_b16 v[74:75], v40 offset:512
    ds_read_b64_tr_b16 v[76:77], v40 offset:4096
    ds_read_b64_tr_b16 v[78:79], v40 offset:4608
    s_waitcnt lgkmcnt(4)
    v_add_f32 v68, v68, v238
    v_add_f32 v69, v69, v239
    v_add_f32 v64, v64, v240
    v_add_f32 v65, v65, v241
    v_add_f32 v66, v66, v242
    v_cvt_pk_bf16_f32 v68, v68, v69
    v_cvt_pk_bf16_f32 v64, v64, v65
    v_cvt_pk_bf16_f32 v66, v66, v66
    ds_write_b16 v44, v68 offset:1024
    ds_write_b16_d16_hi v44, v68 offset:1032
    ds_write_b16 v44, v64 offset:2048
    ds_write_b16_d16_hi v44, v64 offset:3072
    ds_write_b16 v44, v66 offset:4096
hh_k4_kernel_b1h1_join:
    s_waitcnt lgkmcnt(3)
    buffer_store_dwordx4 v[72:75], v41, s[40:43], 0 offen sc1
    buffer_store_dwordx4 v[76:79], v41, s[40:43], 0 offen offset:64 sc1
    s_waitcnt lgkmcnt(0)
    s_barrier
    ds_read_u16 v80, v22
    ds_read_u16 v81, v23
    ds_read_u16 v82, v24
    ds_read_u16 v83, v25
    ds_read_u16 v84, v26
    ds_read_u16 v85, v27
    ds_read_u16 v86, v28
    ds_read_u16 v87, v29
    ds_read_u16 v88, v30
    ds_read_u16 v89, v31
    ds_read_u16 v90, v32
    ds_read_u16 v91, v33
    ds_read_u16 v92, v34
    ds_read_u16 v93, v35
    ds_read_u16 v94, v36
    ds_read_u16 v95, v37
    ds_read_u16 v96, v38
    ds_read_u16 v97, v39
    v_mov_b32 v3, s49
    ds_read_u16 v100, v3
    s_mov_b32 s30, 4160
    s_waitcnt lgkmcnt(10)
    v_lshl_or_b32 v104, v81, 16, v80
    v_lshl_or_b32 v105, v83, 16, v82
    v_lshl_or_b32 v106, v85, 16, v84
    v_lshl_or_b32 v107, v87, 16, v86
    v_lshl_or_b32 v108, v82, 16, v81
    v_lshl_or_b32 v109, v84, 16, v83
    v_lshl_or_b32 v110, v86, 16, v85
    v_lshl_or_b32 v111, v88, 16, v87
    buffer_store_dwordx4 v[104:107], v45, s[44:47], 0 offen
    buffer_store_dwordx4 v[108:111], v45, s[44:47], s30 offen
    s_waitcnt lgkmcnt(0)
    v_lshl_or_b32 v112, v90, 16, v89
    v_lshl_or_b32 v113, v92, 16, v91
    v_lshl_or_b32 v114, v94, 16, v93
    v_lshl_or_b32 v115, v96, 16, v95
    v_lshl_or_b32 v116, v91, 16, v90
    v_lshl_or_b32 v117, v93, 16, v92
    v_lshl_or_b32 v118, v95, 16, v94
    v_lshl_or_b32 v119, v97, 16, v96
    buffer_store_dwordx4 v[112:115], v45, s[44:47], 0 offen offset:2048
    buffer_store_dwordx4 v[116:119], v45, s[44:47], s30 offen offset:2048
    s_cmp_eq_u32 s29, 1
    s_cbranch_scc1 hh_k4_kernel_b1end
    v_cmp_eq_u32 vcc, 0, v1
    s_waitcnt lgkmcnt(0)
    s_nop 0
    v_cndmask_b32 v100, 0, v100, vcc
    v_mov_b32 v101, 0
    v_mov_b32 v102, 0
    v_mov_b32 v103, 0
    v_and_b32 v3, 1, v1
    v_bfe_u32 v4, v1, 1, 1
    v_mul_u32_u24 v4, 4160, v4
    v_lshl_add_u32 v3, v3, 4, v4
    v_add_u32 v3, 4096, v3
    s_mov_b64 exec, 15
    buffer_store_dwordx4 v[100:103], v3, s[44:47], 0 offen
hh_k4_kernel_b1end:
    s_load_dwordx2 s[4:5], s[0:1], 24
    s_mov_b64 exec, -1
    s_mul_i32 s30, s26, 1792
    v_lshlrev_b32 v2, 4, v0
    s_waitcnt lgkmcnt(0)
    s_add_u32 s12, s4, s30
    s_addc_u32 s13, s5, 0
    s_mov_b32 s14, 1792
    s_mov_b32 s15, 0x00020000
    buffer_load_dwordx4 v[8:11], v2, s[12:15], 0 offen
    s_mov_b64 exec, -1
    s_lshl_b32 s30, s33, 10
    s_add_u32 s30, s30, 14729216
    s_add_u32 s4, s24, s30
    s_addc_u32 s5, s25, 0
    s_mov_b32 s6, 1024
    s_mov_b32 s7, 0x00020000
    s_mov_b32 s16, s54
    s_mov_b32 s17, s55
    s_mov_b32 s18, 4
    s_mov_b32 s19, 0x00020000
    v_mov_b32 v2, 0
    s_cmp_eq_u32 s27, 0
    s_cbranch_scc0 hh_k4_kernel_b1e_nold
    s_mov_b64 exec, 1
    buffer_load_dword v3, v2, s[16:19], 0 offen sc1
    s_mov_b64 exec, -1
hh_k4_kernel_b1e_nold:
    s_waitcnt vmcnt(0) lgkmcnt(0)
    s_barrier
    s_cmp_eq_u32 s27, 0
    s_cbranch_scc0 hh_k4_kernel_b1e_nosig
    v_readfirstlane_b32 s31, v3
    s_cmp_lg_u32 s31, 0
    s_cbranch_scc1 hh_k4_kernel_b1e_rdy
    s_mov_b64 exec, 1
    v_mov_b32 v2, 0
    s_mov_b32 s30, 0x100000
hh_k4_kernel_b1e_init:
    buffer_load_dword v3, v2, s[16:19], 0 offen sc1
    s_waitcnt vmcnt(0)
    v_readfirstlane_b32 s31, v3
    s_cmp_ge_u32 s31, 1
    s_cbranch_scc1 hh_k4_kernel_b1e_init_ok
    s_sub_u32 s30, s30, 1
    s_cmp_lg_u32 s30, 0
    s_cbranch_scc1 hh_k4_kernel_b1e_init
hh_k4_kernel_b1e_init_ok:
    s_mov_b64 exec, -1
hh_k4_kernel_b1e_rdy:
    s_mov_b64 exec, 0xff
    v_mov_b32 v3, 1
    v_lshlrev_b32 v2, 7, v1
    buffer_atomic_add v3, v2, s[4:7], 0 offen sc1
    s_mov_b64 exec, -1
hh_k4_kernel_b1e_nosig:
    s_load_dwordx2 s[10:11], s[0:1], 120
    s_load_dwordx2 s[6:7], s[0:1], 104
    s_sub_u32 s12, s2, 256
    v_lshrrev_b32 v2, 6, v0
    v_and_b32 v1, 63, v0
    v_readfirstlane_b32 s13, v2
    s_lshr_b32 s14, s13, 1
    s_and_b32 s15, s13, 1
    s_lshl_b32 s30, s12, 1
    s_add_u32 s30, s30, s14
    s_mul_i32 s28, s14, 14336
    v_lshlrev_b32 v5, 4, v1
    s_mul_i32 s31, s15, 5120
    v_add_u32 v2, s31, v5
    v_add_u32 v3, 4096, v2
    s_lshl_b32 s32, s15, 11
    v_add_u32 v4, s32, v5
    s_add_u32 s33, s28, s31
    s_add_u32 s34, s28, s32
    s_add_u32 s34, s34, 10240
    s_mul_i32 s35, s30, 8320
    s_add_u32 s35, s35, 5242880
    s_lshl_b32 s36, s30, 12
    s_add_u32 s37, s36, 9437184
    s_add_u32 s36, s36, 11534336
    s_mov_b32 m0, s33
    s_waitcnt lgkmcnt(0)
    s_add_u32 s16, s10, s35
    s_addc_u32 s17, s11, 0
    s_mov_b32 s18, 8320
    s_mov_b32 s19, 0x00020000
    s_add_u32 s20, s10, s37
    s_addc_u32 s21, s11, 0
    s_mov_b32 s22, 4096
    s_mov_b32 s23, 0x00020000
    buffer_load_dwordx4 v2, s[16:19], 0 offen lds
    buffer_load_dwordx4 v2, s[16:19], 0 offen offset:1024 lds
    buffer_load_dwordx4 v2, s[16:19], 0 offen offset:2048 lds
    buffer_load_dwordx4 v2, s[16:19], 0 offen offset:3072 lds
    s_add_u32 m0, s33, 4096
    s_add_u32 s24, s10, s36
    s_addc_u32 s25, s11, 0
    s_mov_b32 s26, 4096
    s_mov_b32 s27, 0x00020000
    buffer_load_dwordx4 v3, s[16:19], 0 offen lds
    s_lshr_b32 s38, s12, 5
    s_lshl_b32 s44, s38, 10
    s_add_u32 s44, s44, 14729216
    s_add_u32 s40, s10, s44
    s_addc_u32 s41, s11, 0
    s_mov_b32 s42, 1024
    s_mov_b32 s43, 0x00020000
    s_cmp_eq_u32 s13, 0
    s_cbranch_scc0 hh_k4_kernel_b2ut_no
    s_mov_b64 exec, 1
    s_and_b32 s45, s2, 7
    s_lshl_b32 s45, s45, 7
    v_mov_b32 v12, s45
    s_mov_b32 s44, 0x100000
hh_k4_kernel_b2ut:
    buffer_load_dword v13, v12, s[40:43], 0 offen sc1
    s_waitcnt vmcnt(0)
    v_readfirstlane_b32 s45, v13
    s_cmp_ge_u32 s45, 32
    s_cbranch_scc1 hh_k4_kernel_b2ut_ok
    s_sub_u32 s44, s44, 1
    s_cmp_lg_u32 s44, 0
    s_cbranch_scc1 hh_k4_kernel_b2ut
hh_k4_kernel_b2ut_ok:
    s_mov_b64 exec, -1
hh_k4_kernel_b2ut_no:
    s_barrier
    s_mov_b32 m0, s34
    s_nop 0
    buffer_load_dwordx4 v4, s[20:23], 0 offen lds
    buffer_load_dwordx4 v4, s[20:23], 0 offen offset:1024 lds
    v_and_b32 v12, 15, v1
    v_lshrrev_b32 v13, 4, v1
    v_and_b32 v14, 1, v12
    v_mul_u32_u24 v14, 4158, v14
    v_lshlrev_b32 v15, 4, v13
    v_add_u32 v14, v14, v15
    v_lshlrev_b32 v15, 1, v12
    v_sub_u32 v14, v14, v15
    s_lshl_b32 s31, s15, 8
    s_sub_u32 s32, s28, s31
    s_add_u32 s33, s32, 3360
    v_add_u32 v4, s33, v14
    s_add_u32 s33, s32, 2336
    v_add_u32 v5, s33, v14
    s_add_u32 s33, s32, 1312
    v_add_u32 v6, s33, v14
    s_add_u32 s33, s32, 288
    v_add_u32 v7, s33, v14
    v_lshlrev_b32 v14, 5, v12
    v_lshl_add_u32 v14, v13, 4, v14
    s_add_u32 s33, s32, 10016
    v_add_u32 v8, s33, v14
    v_lshlrev_b32 v14, 5, v12
    v_lshrrev_b32 v15, 1, v13
    v_lshl_add_u32 v14, v15, 4, v14
    v_and_b32 v15, 1, v13
    v_lshl_add_u32 v14, v15, 9, v14
    s_lshl_b32 s33, s15, 11
    v_add_u32 v9, s33, v14
    s_lshl_b32 s33, s13, 12
    s_add_u32 s33, s33, 28672
    v_lshlrev_b32 v14, 4, v1
    v_add_u32 v10, s33, v14
    s_xor_b32 s34, s13, 1
    s_lshl_b32 s34, s34, 12
    s_add_u32 s34, s34, 28672
    v_add_u32 v11, s34, v14
    s_waitcnt vmcnt(0)
    s_barrier
    ds_read2_b32 v[16:17], v4 offset0:176 offset1:177
    ds_read2_b32 v[18:19], v4 offset0:178 offset1:179
    ds_read_b128 v[80:83], v8 offset:192
    ds_read2_b32 v[20:21], v4 offset0:48 offset1:49
    ds_read2_b32 v[22:23], v4 offset0:50 offset1:51
    ds_read_b128 v[84:87], v8 offset:704
    ds_read2_b32 v[24:25], v5 offset0:176 offset1:177
    ds_read2_b32 v[26:27], v5 offset0:178 offset1:179
    ds_read_b128 v[88:91], v8 offset:1216
    ds_read2_b32 v[28:29], v5 offset0:48 offset1:49
    ds_read2_b32 v[30:31], v5 offset0:50 offset1:51
    ds_read_b128 v[92:95], v8 offset:1728
    ds_read2_b32 v[32:33], v6 offset0:176 offset1:177
    ds_read2_b32 v[34:35], v6 offset0:178 offset1:179
    ds_read_b128 v[96:99], v8 offset:2240
    s_waitcnt lgkmcnt(12)
    v_mfma_f32_16x16x32_bf16 v[144:147], v[16:19], v[80:83], 0
    ds_read2_b32 v[36:37], v6 offset0:48 offset1:49
    s_waitcnt lgkmcnt(10)
    v_mfma_f32_16x16x32_bf16 v[148:151], v[16:19], v[84:87], 0
    ds_read2_b32 v[38:39], v6 offset0:50 offset1:51
    v_mfma_f32_16x16x32_bf16 v[148:151], v[20:23], v[80:83], v[148:151]
    ds_read_b128 v[100:103], v8 offset:2752
    v_mfma_f32_16x16x32_bf16 v[152:155], v[20:23], v[84:87], 0
    ds_read2_b32 v[40:41], v7 offset0:176 offset1:177
    s_waitcnt lgkmcnt(10)
    v_mfma_f32_16x16x32_bf16 v[152:155], v[16:19], v[88:91], v[152:155]
    ds_read2_b32 v[42:43], v7 offset0:178 offset1:179
    v_mfma_f32_16x16x32_bf16 v[152:155], v[24:27], v[80:83], v[152:155]
    ds_read_b128 v[104:107], v8 offset:3264
    v_mfma_f32_16x16x32_bf16 v[156:159], v[20:23], v[88:91], 0
    ds_read2_b32 v[44:45], v7 offset0:48 offset1:49
    v_mfma_f32_16x16x32_bf16 v[156:159], v[24:27], v[84:87], v[156:159]
    ds_read2_b32 v[46:47], v7 offset0:50 offset1:51
    v_mfma_f32_16x16x32_bf16 v[160:163], v[24:27], v[88:91], 0
    ds_read_b128 v[108:111], v8 offset:3776
    s_waitcnt lgkmcnt(12)
    v_mfma_f32_16x16x32_bf16 v[156:159], v[16:19], v[92:95], v[156:159]
    ds_read2_b32 v[48:49], v4 offset0:160 offset1:161
    v_mfma_f32_16x16x32_bf16 v[156:159], v[28:31], v[80:83], v[156:159]
    ds_read2_b32 v[50:51], v4 offset0:162 offset1:163
    v_mfma_f32_16x16x32_bf16 v[160:163], v[20:23], v[92:95], v[160:163]
    ds_read_b128 v[112:115], v8 offset:128
    v_mfma_f32_16x16x32_bf16 v[160:163], v[28:31], v[84:87], v[160:163]
    s_waitcnt lgkmcnt(11)
    ds_read2_b32 v[52:53], v4 offset0:32 offset1:33
    v_mfma_f32_16x16x32_bf16 v[164:167], v[24:27], v[92:95], 0
    ds_read2_b32 v[54:55], v4 offset0:34 offset1:35
    v_mfma_f32_16x16x32_bf16 v[164:167], v[28:31], v[88:91], v[164:167]
    ds_read_b128 v[116:119], v8 offset:640
    v_mfma_f32_16x16x32_bf16 v[168:171], v[28:31], v[92:95], 0
    ds_read2_b32 v[56:57], v5 offset0:160 offset1:161
    v_mfma_f32_16x16x32_bf16 v[160:163], v[16:19], v[96:99], v[160:163]
    s_waitcnt lgkmcnt(11)
    ds_read2_b32 v[58:59], v5 offset0:162 offset1:163
    v_mfma_f32_16x16x32_bf16 v[160:163], v[32:35], v[80:83], v[160:163]
    ds_read_b128 v[120:123], v8 offset:1152
    v_mfma_f32_16x16x32_bf16 v[164:167], v[20:23], v[96:99], v[164:167]
    ds_read2_b32 v[60:61], v5 offset0:32 offset1:33
    v_mfma_f32_16x16x32_bf16 v[164:167], v[32:35], v[84:87], v[164:167]
    ds_read2_b32 v[62:63], v5 offset0:34 offset1:35
    v_mfma_f32_16x16x32_bf16 v[168:171], v[24:27], v[96:99], v[168:171]
    s_waitcnt lgkmcnt(11)
    ds_read_b128 v[124:127], v8 offset:1664
    v_mfma_f32_16x16x32_bf16 v[168:171], v[32:35], v[88:91], v[168:171]
    ds_read2_b32 v[64:65], v6 offset0:160 offset1:161
    v_mfma_f32_16x16x32_bf16 v[172:175], v[28:31], v[96:99], 0
    ds_read2_b32 v[66:67], v6 offset0:162 offset1:163
    v_mfma_f32_16x16x32_bf16 v[172:175], v[32:35], v[92:95], v[172:175]
    ds_read_b128 v[128:131], v8 offset:2176
    v_mfma_f32_16x16x32_bf16 v[164:167], v[16:19], v[100:103], v[164:167]
    s_waitcnt lgkmcnt(11)
    ds_read2_b32 v[68:69], v6 offset0:32 offset1:33
    v_mfma_f32_16x16x32_bf16 v[164:167], v[36:39], v[80:83], v[164:167]
    ds_read2_b32 v[70:71], v6 offset0:34 offset1:35
    v_mfma_f32_16x16x32_bf16 v[168:171], v[20:23], v[100:103], v[168:171]
    ds_read_b128 v[132:135], v8 offset:2688
    v_mfma_f32_16x16x32_bf16 v[168:171], v[36:39], v[84:87], v[168:171]
    ds_read2_b32 v[72:73], v7 offset0:160 offset1:161
    v_mfma_f32_16x16x32_bf16 v[172:175], v[24:27], v[100:103], v[172:175]
    s_waitcnt lgkmcnt(11)
    ds_read2_b32 v[74:75], v7 offset0:162 offset1:163
    v_mfma_f32_16x16x32_bf16 v[172:175], v[36:39], v[88:91], v[172:175]
    ds_read_b128 v[136:139], v8 offset:3200
    v_mfma_f32_16x16x32_bf16 v[168:171], v[16:19], v[104:107], v[168:171]
    ds_read2_b32 v[76:77], v7 offset0:32 offset1:33
    v_mfma_f32_16x16x32_bf16 v[168:171], v[40:43], v[80:83], v[168:171]
    ds_read2_b32 v[78:79], v7 offset0:34 offset1:35
    v_mfma_f32_16x16x32_bf16 v[172:175], v[20:23], v[104:107], v[172:175]
    s_waitcnt lgkmcnt(11)
    ds_read_b128 v[140:143], v8 offset:3712
    v_mfma_f32_16x16x32_bf16 v[172:175], v[40:43], v[84:87], v[172:175]
    v_mfma_f32_16x16x32_bf16 v[172:175], v[16:19], v[108:111], v[172:175]
    v_mfma_f32_16x16x32_bf16 v[172:175], v[44:47], v[80:83], v[172:175]
    v_mfma_f32_16x16x32_bf16 v[144:147], v[48:51], v[112:115], v[144:147]
    ds_read2_b32 v[16:17], v4 offset0:144 offset1:145
    v_mfma_f32_16x16x32_bf16 v[148:151], v[48:51], v[116:119], v[148:151]
    ds_read2_b32 v[18:19], v4 offset0:146 offset1:147
    v_mfma_f32_16x16x32_bf16 v[148:151], v[52:55], v[112:115], v[148:151]
    ds_read_b128 v[80:83], v8 offset:64
    v_mfma_f32_16x16x32_bf16 v[152:155], v[52:55], v[116:119], v[152:155]
    s_waitcnt lgkmcnt(11)
    ds_read2_b32 v[20:21], v4 offset0:16 offset1:17
    v_mfma_f32_16x16x32_bf16 v[152:155], v[48:51], v[120:123], v[152:155]
    ds_read2_b32 v[22:23], v4 offset0:18 offset1:19
    v_mfma_f32_16x16x32_bf16 v[152:155], v[56:59], v[112:115], v[152:155]
    ds_read_b128 v[84:87], v8 offset:576
    v_mfma_f32_16x16x32_bf16 v[156:159], v[52:55], v[120:123], v[156:159]
    ds_read2_b32 v[24:25], v5 offset0:144 offset1:145
    v_mfma_f32_16x16x32_bf16 v[156:159], v[56:59], v[116:119], v[156:159]
    s_waitcnt lgkmcnt(11)
    ds_read2_b32 v[26:27], v5 offset0:146 offset1:147
    v_mfma_f32_16x16x32_bf16 v[160:163], v[56:59], v[120:123], v[160:163]
    ds_read_b128 v[88:91], v8 offset:1088
    v_mfma_f32_16x16x32_bf16 v[156:159], v[48:51], v[124:127], v[156:159]
    ds_read2_b32 v[28:29], v5 offset0:16 offset1:17
    v_mfma_f32_16x16x32_bf16 v[156:159], v[60:63], v[112:115], v[156:159]
    ds_read2_b32 v[30:31], v5 offset0:18 offset1:19
    v_mfma_f32_16x16x32_bf16 v[160:163], v[52:55], v[124:127], v[160:163]
    s_waitcnt lgkmcnt(11)
    ds_read_b128 v[92:95], v8 offset:1600
    v_mfma_f32_16x16x32_bf16 v[160:163], v[60:63], v[116:119], v[160:163]
    ds_read2_b32 v[32:33], v6 offset0:144 offset1:145
    v_mfma_f32_16x16x32_bf16 v[164:167], v[56:59], v[124:127], v[164:167]
    ds_read2_b32 v[34:35], v6 offset0:146 offset1:147
    v_mfma_f32_16x16x32_bf16 v[164:167], v[60:63], v[120:123], v[164:167]
    ds_read_b128 v[96:99], v8 offset:2112
    v_mfma_f32_16x16x32_bf16 v[168:171], v[60:63], v[124:127], v[168:171]
    s_waitcnt lgkmcnt(11)
    ds_read2_b32 v[36:37], v6 offset0:16 offset1:17
    v_mfma_f32_16x16x32_bf16 v[160:163], v[48:51], v[128:131], v[160:163]
    ds_read2_b32 v[38:39], v6 offset0:18 offset1:19
    v_mfma_f32_16x16x32_bf16 v[160:163], v[64:67], v[112:115], v[160:163]
    ds_read_b128 v[100:103], v8 offset:2624
    v_mfma_f32_16x16x32_bf16 v[164:167], v[52:55], v[128:131], v[164:167]
    ds_read2_b32 v[40:41], v7 offset0:144 offset1:145
    v_mfma_f32_16x16x32_bf16 v[164:167], v[64:67], v[116:119], v[164:167]
    s_waitcnt lgkmcnt(11)
    ds_read2_b32 v[42:43], v7 offset0:146 offset1:147
    v_mfma_f32_16x16x32_bf16 v[168:171], v[56:59], v[128:131], v[168:171]
    ds_read_b128 v[104:107], v8 offset:3136
    v_mfma_f32_16x16x32_bf16 v[168:171], v[64:67], v[120:123], v[168:171]
    ds_read2_b32 v[44:45], v7 offset0:16 offset1:17
    v_mfma_f32_16x16x32_bf16 v[172:175], v[60:63], v[128:131], v[172:175]
    ds_read2_b32 v[46:47], v7 offset0:18 offset1:19
    v_mfma_f32_16x16x32_bf16 v[172:175], v[64:67], v[124:127], v[172:175]
    s_waitcnt lgkmcnt(11)
    ds_read_b128 v[108:111], v8 offset:3648
    v_mfma_f32_16x16x32_bf16 v[164:167], v[48:51], v[132:135], v[164:167]
    v_mfma_f32_16x16x32_bf16 v[164:167], v[68:71], v[112:115], v[164:167]
    v_mfma_f32_16x16x32_bf16 v[168:171], v[52:55], v[132:135], v[168:171]
    v_mfma_f32_16x16x32_bf16 v[168:171], v[68:71], v[116:119], v[168:171]
    v_mfma_f32_16x16x32_bf16 v[172:175], v[56:59], v[132:135], v[172:175]
    v_mfma_f32_16x16x32_bf16 v[172:175], v[68:71], v[120:123], v[172:175]
    v_mfma_f32_16x16x32_bf16 v[168:171], v[48:51], v[136:139], v[168:171]
    v_mfma_f32_16x16x32_bf16 v[168:171], v[72:75], v[112:115], v[168:171]
    v_mfma_f32_16x16x32_bf16 v[172:175], v[52:55], v[136:139], v[172:175]
    v_mfma_f32_16x16x32_bf16 v[172:175], v[72:75], v[116:119], v[172:175]
    v_mfma_f32_16x16x32_bf16 v[172:175], v[48:51], v[140:143], v[172:175]
    v_mfma_f32_16x16x32_bf16 v[172:175], v[76:79], v[112:115], v[172:175]
    v_mfma_f32_16x16x32_bf16 v[144:147], v[16:19], v[80:83], v[144:147]
    ds_read2_b32 v[48:49], v4 offset0:128 offset1:129
    v_mfma_f32_16x16x32_bf16 v[148:151], v[16:19], v[84:87], v[148:151]
    ds_read2_b32 v[50:51], v4 offset0:130 offset1:131
    v_mfma_f32_16x16x32_bf16 v[148:151], v[20:23], v[80:83], v[148:151]
    ds_read_b128 v[112:115], v8 offset:0
    v_mfma_f32_16x16x32_bf16 v[152:155], v[20:23], v[84:87], v[152:155]
    s_waitcnt lgkmcnt(11)
    ds_read2_b32 v[52:53], v4 offset0:0 offset1:1
    v_mfma_f32_16x16x32_bf16 v[152:155], v[16:19], v[88:91], v[152:155]
    ds_read2_b32 v[54:55], v4 offset0:2 offset1:3
    v_mfma_f32_16x16x32_bf16 v[152:155], v[24:27], v[80:83], v[152:155]
    ds_read_b128 v[116:119], v8 offset:512
    v_mfma_f32_16x16x32_bf16 v[156:159], v[20:23], v[88:91], v[156:159]
    ds_read2_b32 v[56:57], v5 offset0:128 offset1:129
    v_mfma_f32_16x16x32_bf16 v[156:159], v[24:27], v[84:87], v[156:159]
    s_waitcnt lgkmcnt(11)
    ds_read2_b32 v[58:59], v5 offset0:130 offset1:131
    v_mfma_f32_16x16x32_bf16 v[160:163], v[24:27], v[88:91], v[160:163]
    ds_read_b128 v[120:123], v8 offset:1024
    v_mfma_f32_16x16x32_bf16 v[156:159], v[16:19], v[92:95], v[156:159]
    ds_read2_b32 v[60:61], v5 offset0:0 offset1:1
    v_mfma_f32_16x16x32_bf16 v[156:159], v[28:31], v[80:83], v[156:159]
    ds_read2_b32 v[62:63], v5 offset0:2 offset1:3
    v_mfma_f32_16x16x32_bf16 v[160:163], v[20:23], v[92:95], v[160:163]
    s_waitcnt lgkmcnt(11)
    ds_read_b128 v[124:127], v8 offset:1536
    v_mfma_f32_16x16x32_bf16 v[160:163], v[28:31], v[84:87], v[160:163]
    ds_read2_b32 v[64:65], v6 offset0:128 offset1:129
    v_mfma_f32_16x16x32_bf16 v[164:167], v[24:27], v[92:95], v[164:167]
    ds_read2_b32 v[66:67], v6 offset0:130 offset1:131
    v_mfma_f32_16x16x32_bf16 v[164:167], v[28:31], v[88:91], v[164:167]
    ds_read_b128 v[128:131], v8 offset:2048
    v_mfma_f32_16x16x32_bf16 v[168:171], v[28:31], v[92:95], v[168:171]
    s_waitcnt lgkmcnt(11)
    ds_read2_b32 v[68:69], v6 offset0:0 offset1:1
    v_mfma_f32_16x16x32_bf16 v[160:163], v[16:19], v[96:99], v[160:163]
    ds_read2_b32 v[70:71], v6 offset0:2 offset1:3
    v_mfma_f32_16x16x32_bf16 v[160:163], v[32:35], v[80:83], v[160:163]
    ds_read_b128 v[132:135], v8 offset:2560
    v_mfma_f32_16x16x32_bf16 v[164:167], v[20:23], v[96:99], v[164:167]
    ds_read2_b32 v[72:73], v7 offset0:128 offset1:129
    v_mfma_f32_16x16x32_bf16 v[164:167], v[32:35], v[84:87], v[164:167]
    s_waitcnt lgkmcnt(11)
    ds_read2_b32 v[74:75], v7 offset0:130 offset1:131
    v_mfma_f32_16x16x32_bf16 v[168:171], v[24:27], v[96:99], v[168:171]
    ds_read_b128 v[136:139], v8 offset:3072
    v_mfma_f32_16x16x32_bf16 v[168:171], v[32:35], v[88:91], v[168:171]
    ds_read2_b32 v[76:77], v7 offset0:0 offset1:1
    v_mfma_f32_16x16x32_bf16 v[172:175], v[28:31], v[96:99], v[172:175]
    ds_read2_b32 v[78:79], v7 offset0:2 offset1:3
    v_mfma_f32_16x16x32_bf16 v[172:175], v[32:35], v[92:95], v[172:175]
    s_waitcnt lgkmcnt(11)
    ds_read_b128 v[140:143], v8 offset:3584
    v_mfma_f32_16x16x32_bf16 v[164:167], v[16:19], v[100:103], v[164:167]
    v_mfma_f32_16x16x32_bf16 v[164:167], v[36:39], v[80:83], v[164:167]
    v_mfma_f32_16x16x32_bf16 v[168:171], v[20:23], v[100:103], v[168:171]
    v_mfma_f32_16x16x32_bf16 v[168:171], v[36:39], v[84:87], v[168:171]
    v_mfma_f32_16x16x32_bf16 v[172:175], v[24:27], v[100:103], v[172:175]
    v_mfma_f32_16x16x32_bf16 v[172:175], v[36:39], v[88:91], v[172:175]
    v_mfma_f32_16x16x32_bf16 v[168:171], v[16:19], v[104:107], v[168:171]
    v_mfma_f32_16x16x32_bf16 v[168:171], v[40:43], v[80:83], v[168:171]
    v_mfma_f32_16x16x32_bf16 v[172:175], v[20:23], v[104:107], v[172:175]
    v_mfma_f32_16x16x32_bf16 v[172:175], v[40:43], v[84:87], v[172:175]
    v_mfma_f32_16x16x32_bf16 v[172:175], v[16:19], v[108:111], v[172:175]
    v_mfma_f32_16x16x32_bf16 v[172:175], v[44:47], v[80:83], v[172:175]
    v_mfma_f32_16x16x32_bf16 v[144:147], v[48:51], v[112:115], v[144:147]
    v_mfma_f32_16x16x32_bf16 v[148:151], v[48:51], v[116:119], v[148:151]
    v_mfma_f32_16x16x32_bf16 v[148:151], v[52:55], v[112:115], v[148:151]
    v_mfma_f32_16x16x32_bf16 v[152:155], v[52:55], v[116:119], v[152:155]
    v_mfma_f32_16x16x32_bf16 v[152:155], v[48:51], v[120:123], v[152:155]
    v_mfma_f32_16x16x32_bf16 v[152:155], v[56:59], v[112:115], v[152:155]
    v_mfma_f32_16x16x32_bf16 v[156:159], v[52:55], v[120:123], v[156:159]
    v_mfma_f32_16x16x32_bf16 v[156:159], v[56:59], v[116:119], v[156:159]
    v_mfma_f32_16x16x32_bf16 v[160:163], v[56:59], v[120:123], v[160:163]
    v_mfma_f32_16x16x32_bf16 v[156:159], v[48:51], v[124:127], v[156:159]
    v_mfma_f32_16x16x32_bf16 v[156:159], v[60:63], v[112:115], v[156:159]
    v_mfma_f32_16x16x32_bf16 v[160:163], v[52:55], v[124:127], v[160:163]
    v_mfma_f32_16x16x32_bf16 v[160:163], v[60:63], v[116:119], v[160:163]
    v_mfma_f32_16x16x32_bf16 v[164:167], v[56:59], v[124:127], v[164:167]
    v_mfma_f32_16x16x32_bf16 v[164:167], v[60:63], v[120:123], v[164:167]
    v_mfma_f32_16x16x32_bf16 v[168:171], v[60:63], v[124:127], v[168:171]
    s_waitcnt lgkmcnt(9)
    v_mfma_f32_16x16x32_bf16 v[160:163], v[48:51], v[128:131], v[160:163]
    v_mfma_f32_16x16x32_bf16 v[160:163], v[64:67], v[112:115], v[160:163]
    v_mfma_f32_16x16x32_bf16 v[164:167], v[52:55], v[128:131], v[164:167]
    v_mfma_f32_16x16x32_bf16 v[164:167], v[64:67], v[116:119], v[164:167]
    v_mfma_f32_16x16x32_bf16 v[168:171], v[56:59], v[128:131], v[168:171]
    v_mfma_f32_16x16x32_bf16 v[168:171], v[64:67], v[120:123], v[168:171]
    v_mfma_f32_16x16x32_bf16 v[172:175], v[60:63], v[128:131], v[172:175]
    v_mfma_f32_16x16x32_bf16 v[172:175], v[64:67], v[124:127], v[172:175]
    s_waitcnt lgkmcnt(6)
    v_mfma_f32_16x16x32_bf16 v[164:167], v[48:51], v[132:135], v[164:167]
    v_mfma_f32_16x16x32_bf16 v[164:167], v[68:71], v[112:115], v[164:167]
    v_mfma_f32_16x16x32_bf16 v[168:171], v[52:55], v[132:135], v[168:171]
    v_mfma_f32_16x16x32_bf16 v[168:171], v[68:71], v[116:119], v[168:171]
    v_mfma_f32_16x16x32_bf16 v[172:175], v[56:59], v[132:135], v[172:175]
    v_mfma_f32_16x16x32_bf16 v[172:175], v[68:71], v[120:123], v[172:175]
    s_waitcnt lgkmcnt(3)
    v_mfma_f32_16x16x32_bf16 v[168:171], v[48:51], v[136:139], v[168:171]
    v_mfma_f32_16x16x32_bf16 v[168:171], v[72:75], v[112:115], v[168:171]
    v_mfma_f32_16x16x32_bf16 v[172:175], v[52:55], v[136:139], v[172:175]
    v_mfma_f32_16x16x32_bf16 v[172:175], v[72:75], v[116:119], v[172:175]
    s_waitcnt lgkmcnt(0)
    v_mfma_f32_16x16x32_bf16 v[172:175], v[48:51], v[140:143], v[172:175]
    v_mfma_f32_16x16x32_bf16 v[172:175], v[76:79], v[112:115], v[172:175]
    s_nop 7
    s_cmp_eq_u32 s15, 1
    s_cbranch_scc1 hh_k4_kernel_b2h1
    ds_write_b128 v10, v[160:163] offset:0
    ds_write_b128 v10, v[164:167] offset:1024
    ds_write_b128 v10, v[168:171] offset:2048
    ds_write_b128 v10, v[172:175] offset:3072
    s_waitcnt lgkmcnt(0)
    s_barrier
    ds_read_b128 v[16:19], v11 offset:0
    ds_read_b128 v[20:23], v11 offset:1024
    ds_read_b128 v[24:27], v11 offset:2048
    ds_read_b128 v[28:31], v11 offset:3072
    s_waitcnt lgkmcnt(3)
    v_add_f32 v16, v16, v144
    v_add_f32 v17, v17, v145
    v_add_f32 v18, v18, v146
    v_add_f32 v19, v19, v147
    v_cvt_pk_bf16_f32 v40, v16, v17
    v_cvt_pk_bf16_f32 v41, v18, v19
    s_waitcnt lgkmcnt(2)
    v_add_f32 v20, v20, v148
    v_add_f32 v21, v21, v149
    v_add_f32 v22, v22, v150
    v_add_f32 v23, v23, v151
    v_cvt_pk_bf16_f32 v42, v20, v21
    v_cvt_pk_bf16_f32 v43, v22, v23
    s_nop 0
    v_permlane16_swap_b32 v40, v42
    v_permlane16_swap_b32 v41, v43
    buffer_store_dwordx4 v[40:43], v9, s[24:27], 0 offen sc1
    s_waitcnt lgkmcnt(1)
    v_add_f32 v24, v24, v152
    v_add_f32 v25, v25, v153
    v_add_f32 v26, v26, v154
    v_add_f32 v27, v27, v155
    v_cvt_pk_bf16_f32 v44, v24, v25
    v_cvt_pk_bf16_f32 v45, v26, v27
    s_waitcnt lgkmcnt(0)
    v_add_f32 v28, v28, v156
    v_add_f32 v29, v29, v157
    v_add_f32 v30, v30, v158
    v_add_f32 v31, v31, v159
    v_cvt_pk_bf16_f32 v46, v28, v29
    v_cvt_pk_bf16_f32 v47, v30, v31
    s_nop 0
    v_permlane16_swap_b32 v44, v46
    v_permlane16_swap_b32 v45, v47
    buffer_store_dwordx4 v[44:47], v9, s[24:27], 0 offen offset:1024 sc1
    s_branch hh_k4_kernel_b2tail
hh_k4_kernel_b2h1:
    ds_write_b128 v10, v[144:147] offset:0
    ds_write_b128 v10, v[148:151] offset:1024
    ds_write_b128 v10, v[152:155] offset:2048
    ds_write_b128 v10, v[156:159] offset:3072
    s_waitcnt lgkmcnt(0)
    s_barrier
    ds_read_b128 v[16:19], v11 offset:0
    ds_read_b128 v[20:23], v11 offset:1024
    ds_read_b128 v[24:27], v11 offset:2048
    ds_read_b128 v[28:31], v11 offset:3072
    s_waitcnt lgkmcnt(3)
    v_add_f32 v16, v16, v160
    v_add_f32 v17, v17, v161
    v_add_f32 v18, v18, v162
    v_add_f32 v19, v19, v163
    v_cvt_pk_bf16_f32 v40, v16, v17
    v_cvt_pk_bf16_f32 v41, v18, v19
    s_waitcnt lgkmcnt(2)
    v_add_f32 v20, v20, v164
    v_add_f32 v21, v21, v165
    v_add_f32 v22, v22, v166
    v_add_f32 v23, v23, v167
    v_cvt_pk_bf16_f32 v42, v20, v21
    v_cvt_pk_bf16_f32 v43, v22, v23
    s_nop 0
    v_permlane16_swap_b32 v40, v42
    v_permlane16_swap_b32 v41, v43
    buffer_store_dwordx4 v[40:43], v9, s[24:27], 0 offen sc1
    s_waitcnt lgkmcnt(1)
    v_add_f32 v24, v24, v168
    v_add_f32 v25, v25, v169
    v_add_f32 v26, v26, v170
    v_add_f32 v27, v27, v171
    v_cvt_pk_bf16_f32 v44, v24, v25
    v_cvt_pk_bf16_f32 v45, v26, v27
    s_waitcnt lgkmcnt(0)
    v_add_f32 v28, v28, v172
    v_add_f32 v29, v29, v173
    v_add_f32 v30, v30, v174
    v_add_f32 v31, v31, v175
    v_cvt_pk_bf16_f32 v46, v28, v29
    v_cvt_pk_bf16_f32 v47, v30, v31
    s_nop 0
    v_permlane16_swap_b32 v44, v46
    v_permlane16_swap_b32 v45, v47
    buffer_store_dwordx4 v[44:47], v9, s[24:27], 0 offen offset:1024 sc1
hh_k4_kernel_b2tail:
    s_lshr_b32 s30, s12, 5
    s_and_b32 s31, s12, 31
    s_lshl_b32 s37, s30, 10
    s_add_u32 s37, s37, 14696448
    s_add_u32 s16, s10, s37
    s_addc_u32 s17, s11, 0
    s_mov_b32 s18, 1024
    s_mov_b32 s19, 0x00020000
    s_lshl_b32 s36, s30, 7
    s_lshl_b32 s37, s30, 18
    s_lshl_b32 s38, s31, 7
    s_add_u32 s37, s37, s38
    s_add_u32 s37, s37, 11534336
    s_add_u32 s20, s10, s37
    s_addc_u32 s21, s11, 0
    s_mov_b32 s22, 258176
    s_mov_b32 s23, 0x00020000
    s_mul_i32 s37, s31, 114688
    s_add_u32 s37, s37, s36
    s_add_u32 s37, s37, 896
    s_add_u32 s32, s6, s37
    s_addc_u32 s33, s7, 0
    s_mov_b32 s34, 113024
    s_mov_b32 s35, 0x00020000
    v_lshrrev_b32 v12, 3, v1
    s_lshl_b32 s36, s13, 4
    v_add_u32 v12, s36, v12
    v_bfe_u32 v13, v1, 4, 1
    v_lshlrev_b32 v13, 2, v13
    v_and_b32 v14, 7, v1
    v_xor_b32 v13, v13, v14
    v_lshlrev_b32 v12, 12, v12
    v_lshl_add_u32 v2, v13, 4, v12
    v_add_u32 v3, 32768, v2
    s_lshl_b32 s36, s13, 11
    v_lshlrev_b32 v12, 4, v1
    v_add_u32 v4, s36, v12
    v_lshrrev_b32 v12, 4, v1
    v_bfe_u32 v13, v1, 2, 2
    v_and_b32 v14, 3, v1
    v_lshl_add_u32 v15, v12, 3, v13
    v_lshlrev_b32 v15, 7, v15
    v_lshrrev_b32 v16, 1, v14
    s_lshl_b32 s36, s13, 1
    v_add_u32 v16, s36, v16
    v_lshrrev_b32 v17, 1, v13
    v_lshlrev_b32 v17, 2, v17
    v_xor_b32 v16, v16, v17
    v_lshl_add_u32 v15, v16, 4, v15
    v_and_b32 v14, 1, v14
    v_lshl_add_u32 v5, v14, 3, v15
    v_and_b32 v13, 15, v1
    s_lshl_b32 s36, s13, 4
    v_add_u32 v13, s36, v13
    v_mul_u32_u24 v13, 144, v13
    v_lshl_add_u32 v6, v12, 4, v13
    v_add_u32 v6, 8192, v6
    v_lshrrev_b32 v12, 3, v0
    v_and_b32 v13, 7, v0
    v_mul_u32_u24 v14, 144, v12
    v_lshl_add_u32 v7, v13, 4, v14
    v_mul_u32_u24 v14, 1792, v12
    v_lshl_add_u32 v8, v13, 4, v14
    s_waitcnt vmcnt(0)
    s_barrier
    s_cmp_eq_u32 s13, 0
    s_cbranch_scc0 hh_k4_kernel_b2_nopoll
    s_mov_b64 exec, 0xff
    v_mov_b32 v14, 1
    v_lshlrev_b32 v13, 7, v1
    buffer_atomic_add v14, v13, s[16:19], 0 offen sc1
    s_mov_b64 exec, -1
    s_mov_b64 exec, 1
    s_and_b32 s37, s2, 7
    s_lshl_b32 s37, s37, 7
    v_mov_b32 v13, s37
    s_mov_b32 s36, 0x100000
hh_k4_kernel_b2_poll:
    buffer_load_dword v14, v13, s[16:19], 0 offen sc1
    s_waitcnt vmcnt(0)
    v_readfirstlane_b32 s37, v14
    s_cmp_ge_u32 s37, 32
    s_cbranch_scc1 hh_k4_kernel_b2_poll_ok
    s_sub_u32 s36, s36, 1
    s_cmp_lg_u32 s36, 0
    s_cbranch_scc1 hh_k4_kernel_b2_poll
hh_k4_kernel_b2_poll_ok:
    s_mov_b64 exec, -1
hh_k4_kernel_b2_nopoll:
    s_barrier
    buffer_load_dwordx4 v[16:19], v2, s[20:23], 0 offen sc1
    buffer_load_dwordx4 v[20:23], v3, s[20:23], 0 offen sc1
    s_waitcnt vmcnt(1)
    ds_write_b128 v4, v[16:19] offset:0
    s_waitcnt vmcnt(0)
    ds_write_b128 v4, v[20:23] offset:1024
    s_waitcnt lgkmcnt(0)
    s_barrier
    ds_read_b64_tr_b16 v[32:33], v5 offset:0
    ds_read_b64_tr_b16 v[34:35], v5 offset:512
    ds_read_b64_tr_b16 v[36:37], v5 offset:4096
    ds_read_b64_tr_b16 v[38:39], v5 offset:4608
    s_waitcnt lgkmcnt(0)
    ds_write_b128 v6, v[32:35] offset:0
    ds_write_b128 v6, v[36:39] offset:64
    s_waitcnt lgkmcnt(0)
    s_barrier
    ds_read_b128 v[48:51], v7 offset:8192
    ds_read_b128 v[52:55], v7 offset:12800
    v_add_u32 v3, 57344, v8
    s_waitcnt lgkmcnt(1)
    buffer_store_dwordx4 v[48:51], v8, s[32:35], 0 offen
    s_waitcnt lgkmcnt(0)
    buffer_store_dwordx4 v[52:55], v3, s[32:35], 0 offen
    s_endpgm
hh_k4_kernel_end:
    s_endpgm
.section .rodata,"a"
.p2align 6
.amdhsa_kernel hh_k4_kernel
  .amdhsa_next_free_vgpr 256
  .amdhsa_next_free_sgpr 102
  .amdhsa_accum_offset 256
  .amdhsa_group_segment_fixed_size 0
  .amdhsa_kernarg_size 128
  .amdhsa_user_sgpr_count 2
  .amdhsa_user_sgpr_kernarg_segment_ptr 1
  .amdhsa_system_sgpr_workgroup_id_x 1
.end_amdhsa_kernel
```
